```python
import torch

def _softmax(x, axis=-1):
    return torch.softmax(x, dim=axis)
def _gelu(x):
    return torch.nn.functional.gelu(x, approximate="tanh")
def _silu(x):
    return torch.nn.functional.silu(x)
def _sigmoid(x):
    return torch.sigmoid(x)
def _layernorm(x, axis=-1, eps=1e-5):
    m = x.mean(dim=axis, keepdim=True)
    v = x.var(dim=axis, keepdim=True, unbiased=False)
    return (x - m) / torch.sqrt(v + eps)
def _scatter_add(tgt, idx, src, axis=0):
    return tgt.clone().index_add_(axis, idx, src)
def _segment_sum(src, seg, n):
    out = torch.zeros((n,) + src.shape[1:], dtype=src.dtype)
    return out.index_add_(0, seg, src)
def _pad(x, pw):
    flat = tuple(v for pair in reversed(pw) for v in pair)
    return torch.nn.functional.pad(x, flat)

kernel_name = 'concat_heads__softmax_full_mha__mha_block__prompt'

def setup_inputs():

    _w = (lambda a: (lambda t: t.to(torch.bfloat16) if t.is_floating_point() else t)(torch.as_tensor(a)))
    def _A_setup():
        B, S, D = 1, 2048, 448
        return {
            "x": _w((lambda *s: torch.randn(*s, dtype=torch.bfloat16) * 0.2)(B, S, D)),
            "wqkv": _w((lambda *s: torch.randn(*s, dtype=torch.bfloat16) * 0.2)(D, 3 * D)),
            "wo": _w((lambda *s: torch.randn(*s, dtype=torch.bfloat16) * 0.05)(D, D)),
        }
    _A_in = _A_setup()

    def _B_setup():
        B, S, D, H = 1, 2048, 448, 16
        return {
            "x": _w((lambda *s: torch.randn(*s, dtype=torch.bfloat16) * 0.2)(B, S, D)),
            "wqkv": _w((lambda *s: torch.randn(*s, dtype=torch.bfloat16) * 0.2)(D, 3 * D)),
            "wo": _w((lambda *s: torch.randn(*s, dtype=torch.bfloat16) * 0.05)(D, D)),
        }
    _B_in = _B_setup()

    return {
        "A_x": _A_in["x"],
        "A_wqkv": _A_in["wqkv"],
        "A_wo": _A_in["wo"],
        "B_x": _B_in["x"],
        "B_wqkv": _B_in["wqkv"],
        "B_wo": _B_in["wo"],
    }

def reference(A_x, A_wqkv, A_wo, B_x, B_wqkv, B_wo):
    def _A_ref(x, wqkv, wo):
        B, S, D = x.shape
        H = 16; Dh = D // H
        qkv = (lambda x, *d: x.permute(*d))((x @ wqkv).reshape(B, S, 3, H, Dh), 2, 0, 3, 1, 4)
        q, k, v = qkv[0], qkv[1], qkv[2]
        scale = Dh ** -0.5
        scores = torch.einsum("bhqd,bhkd->bhqk", q, k) * scale
        p = _softmax(scores, axis=-1)
        o = torch.einsum("bhqk,bhkd->bhqd", p, v)
        return (lambda x, *d: x.permute(*d))(o, 0, 2, 1, 3).reshape(B, S, D) @ wo

    def _B_ref(x, wqkv, wo):
        B, S, D = x.shape
        H = 16
        Dh = D // H
        qkv = (lambda x, *d: x.permute(*d))((x @ wqkv).reshape(B, S, 3, H, Dh), 2, 0, 3, 1, 4)
        q, k, v = qkv[0], qkv[1], qkv[2]
        scores = torch.einsum("bhqd,bhkd->bhqk", q, k) * (Dh ** -0.5)
        p = _softmax(scores, axis=-1)
        o = torch.einsum("bhqk,bhkd->bhqd", p, v)
        return (lambda x, *d: x.permute(*d))(o, 0, 2, 1, 3).reshape(B, S, D) @ wo

    a = _A_ref(A_x, A_wqkv, A_wo)
    b = _B_ref(B_x, B_wqkv, B_wo)
    return torch.concatenate([a, b], axis=-1)
```

```asm
; @launch grid=(256,1,1) block=(512,1,1) lds=163840
.amdgcn_target "amdgcn-amd-amdhsa--gfx950"
.text
.globl concat_heads__softmax_full_mha__mha_block__prompt_kernel
.p2align 8
.type concat_heads__softmax_full_mha__mha_block__prompt_kernel,@function
concat_heads__softmax_full_mha__mha_block__prompt_kernel:
    s_load_dwordx16 s[84:99], s[0:1], 0
    s_load_dwordx2 s[100:101], s[0:1], 64
    s_cmp_ge_u32 s2, 256
    s_cbranch_scc1 L_end
    s_cmp_ge_u32 s2, 8
    s_cbranch_scc1 L_nocpf
    s_getpc_b64 s[4:5]
L_pcbase:
    s_sub_u32 s4, s4, L_pcbase-concat_heads__softmax_full_mha__mha_block__prompt_kernel
    s_subb_u32 s5, s5, 0
    s_mov_b32 s6, L_codeend-concat_heads__softmax_full_mha__mha_block__prompt_kernel
    s_mov_b32 s7, 0x20000
    v_lshlrev_b32 v20, 7, v0
    buffer_load_dwordx2 v[54:55], v20, s[4:7], 0 offen offset:60
L_nocpf:
    v_lshrrev_b32 v2, 6, v0
    v_and_b32 v1, 63, v0
    v_readfirstlane_b32 s35, v2
    s_and_b32 s67, s2, 7
    s_lshr_b32 s68, s2, 3
    s_lshr_b32 s32, s67, 2
    s_and_b32 s34, s67, 3
    s_lshl_b32 s34, s34, 1
    s_and_b32 s69, s68, 1
    s_add_u32 s34, s34, s69
    s_lshr_b32 s33, s68, 1
    s_lshl_b32 s37, s32, 4
    s_add_u32 s37, s37, s33
    s_cmp_lt_u32 s35, 4
    s_cbranch_scc1 L_compute
    s_and_b32 s35, s35, 3
    s_setprio 3
    v_lshrrev_b32 v12, 2, v1
    v_and_b32 v13, 3, v1
    v_mul_u32_u24 v5, 2688, v12
    v_lshl_add_u32 v5, v13, 4, v5
    v_lshrrev_b32 v12, 3, v1
    v_lshrrev_b32 v13, 4, v1
    v_and_b32 v14, 7, v1
    v_xor_b32 v13, v13, v14
    v_mul_u32_u24 v3, 896, v12
    v_lshl_add_u32 v3, v13, 4, v3
    v_xor_b32 v4, 64, v3
    s_mov_b32 s6, 1835008
    s_mov_b32 s7, 0x20000
    s_mov_b32 s10, 1204224
    s_mov_b32 s11, 0x20000
    s_lshl_b32 s67, s34, 2
    s_add_u32 s67, s67, s35
    s_mul_i32 s40, s67, 57344
    s_mul_i32 s68, s33, 56
    s_cmp_eq_u32 s33, 15
    s_cselect_b32 s69, 8, 0
    s_sub_u32 s68, s68, s69
    s_mul_i32 s48, s35, 43008
    s_add_u32 s48, s48, s68
    s_lshl_b32 s56, s35, 10
    s_lshl_b32 s55, s35, 12
    s_add_u32 s55, s55, 65536
    s_add_u32 s41, s40, 7168
    s_add_u32 s42, s40, 14336
    s_add_u32 s43, s40, 21504
    s_mov_b32 s62, s48
    s_and_b32 s69, s2, 3
    s_mul_i32 s69, s69, 2
    s_mul_i32 s48, s69, 172032
    s_lshl_b32 s68, s69, 7
    s_add_u32 s48, s48, s62
    v_add_u32 v16, s68, v3
    v_add_u32 v17, s68, v4
    s_cmp_eq_u32 s32, 0
    s_waitcnt lgkmcnt(0)
    s_cselect_b64 s[8:9], s[86:87], s[92:93]
    s_cselect_b64 s[4:5], s[84:85], s[90:91]
    s_cselect_b64 s[12:13], s[88:89], s[94:95]
    s_add_u32 m0, s56, 27776
    s_add_u32 s44, s40, 28672
    buffer_load_dwordx4 v5, s[8:11], s48 offen offset:896 lds
    s_add_u32 m0, s56, 129280
    s_add_u32 s45, s40, 35840
    buffer_load_dwordx4 v5, s[8:11], s48 offen offset:1792 lds
    s_add_u32 m0, s56, 0
    s_add_u32 s46, s40, 43008
    buffer_load_dwordx4 v5, s[8:11], s48 offen offset:0 lds
    s_add_u32 m0, s55, 0
    s_add_u32 s47, s40, 50176
    buffer_load_dwordx4 v16, s[4:7], s40 offen lds
    s_add_u32 m0, s55, 1024
    s_mov_b64 s[16:17], s[96:97]
    buffer_load_dwordx4 v17, s[4:7], s41 offen lds
    s_add_u32 m0, s55, 2048
    s_mov_b32 s14, 401408
    buffer_load_dwordx4 v16, s[4:7], s42 offen lds
    s_add_u32 m0, s55, 3072
    s_mov_b32 s15, 0x20000
    buffer_load_dwordx4 v17, s[4:7], s43 offen lds
    s_add_u32 s69, s69, 1
    s_cmp_eq_u32 s69, 7
    s_cselect_b32 s69, 0, s69
    s_mul_i32 s49, s69, 172032
    s_lshl_b32 s68, s69, 7
    s_add_u32 s49, s49, s62
    v_add_u32 v18, s68, v3
    v_add_u32 v19, s68, v4
    s_add_u32 m0, s56, 31872
    s_mov_b32 s18, 3670016
    buffer_load_dwordx4 v5, s[8:11], s49 offen offset:896 lds
    s_add_u32 m0, s56, 133376
    s_mov_b32 s19, 0x20000
    buffer_load_dwordx4 v5, s[8:11], s49 offen offset:1792 lds
    s_add_u32 m0, s56, 4096
    s_nop 0
    buffer_load_dwordx4 v5, s[8:11], s49 offen offset:0 lds
    s_add_u32 m0, s55, 16384
    s_nop 0
    buffer_load_dwordx4 v18, s[4:7], s40 offen lds
    s_add_u32 m0, s55, 17408
    s_nop 0
    buffer_load_dwordx4 v19, s[4:7], s41 offen lds
    s_add_u32 m0, s55, 18432
    s_nop 0
    buffer_load_dwordx4 v18, s[4:7], s42 offen lds
    s_add_u32 m0, s55, 19456
    s_nop 0
    buffer_load_dwordx4 v19, s[4:7], s43 offen lds
    s_add_u32 s69, s69, 1
    s_cmp_eq_u32 s69, 7
    s_cselect_b32 s69, 0, s69
    s_mul_i32 s50, s69, 172032
    s_lshl_b32 s68, s69, 7
    s_add_u32 s50, s50, s62
    v_add_u32 v20, s68, v3
    v_add_u32 v21, s68, v4
    s_add_u32 m0, s56, 35968
    s_nop 0
    buffer_load_dwordx4 v5, s[8:11], s50 offen offset:896 lds
    s_add_u32 m0, s56, 137472
    s_nop 0
    buffer_load_dwordx4 v5, s[8:11], s50 offen offset:1792 lds
    s_add_u32 m0, s56, 8192
    s_nop 0
    buffer_load_dwordx4 v5, s[8:11], s50 offen offset:0 lds
    s_add_u32 m0, s55, 32768
    s_nop 0
    buffer_load_dwordx4 v20, s[4:7], s40 offen lds
    s_add_u32 m0, s55, 33792
    s_nop 0
    buffer_load_dwordx4 v21, s[4:7], s41 offen lds
    s_add_u32 m0, s55, 34816
    s_nop 0
    buffer_load_dwordx4 v20, s[4:7], s42 offen lds
    s_add_u32 m0, s55, 35840
    s_nop 0
    buffer_load_dwordx4 v21, s[4:7], s43 offen lds
    s_add_u32 s69, s69, 1
    s_cmp_eq_u32 s69, 7
    s_cselect_b32 s69, 0, s69
    s_mul_i32 s51, s69, 172032
    s_lshl_b32 s68, s69, 7
    s_add_u32 s51, s51, s62
    v_add_u32 v22, s68, v3
    v_add_u32 v23, s68, v4
    s_add_u32 s69, s69, 1
    s_cmp_eq_u32 s69, 7
    s_cselect_b32 s69, 0, s69
    s_mul_i32 s52, s69, 172032
    s_lshl_b32 s68, s69, 7
    s_add_u32 s52, s52, s62
    v_add_u32 v24, s68, v3
    v_add_u32 v25, s68, v4
    s_add_u32 s69, s69, 1
    s_cmp_eq_u32 s69, 7
    s_cselect_b32 s69, 0, s69
    s_mul_i32 s53, s69, 172032
    s_lshl_b32 s68, s69, 7
    s_add_u32 s53, s53, s62
    v_add_u32 v26, s68, v3
    v_add_u32 v27, s68, v4
    s_add_u32 s69, s69, 1
    s_cmp_eq_u32 s69, 7
    s_cselect_b32 s69, 0, s69
    s_mul_i32 s54, s69, 172032
    s_lshl_b32 s68, s69, 7
    s_add_u32 s54, s54, s62
    v_add_u32 v28, s68, v3
    v_add_u32 v29, s68, v4
    s_lshl_b32 s67, s37, 18
    s_add_u32 s67, s67, 0
    s_add_u32 s20, s100, s67
    s_addc_u32 s21, s101, 0
    s_mov_b32 s22, 262144
    s_mov_b32 s23, 0x20000
    s_add_u32 s24, s100, 8388608
    s_addc_u32 s25, s101, 0
    s_mov_b32 s26, 4194304
    s_mov_b32 s27, 0x20000
    s_add_u32 s28, s100, 12582912
    s_addc_u32 s29, s101, 0
    s_mov_b32 s30, 524288
    s_mov_b32 s31, 0x20000
    s_lshl_b32 s67, s32, 8
    s_add_u32 s94, s28, s67
    s_addc_u32 s95, s29, 0
    s_load_dword s36, s[94:95], 0
    s_waitcnt vmcnt(14)
    s_barrier
    v_lshlrev_b32 v2, 4, v1
    s_lshl_b32 s67, s35, 13
    v_add_u32 v6, s67, v2
    s_lshl_b32 s86, s34, 15
    s_add_u32 s86, s86, 4096
    s_and_b32 s90, s33, 3
    s_add_u32 m0, s56, 40064
    s_nop 0
    buffer_load_dwordx4 v5, s[8:11], s51 offen offset:896 lds
    s_lshr_b32 s91, s33, 2
    s_lshl_b32 s67, s37, 2
    s_add_u32 s67, s67, s35
    s_lshl_b32 s67, s67, 7
    s_add_u32 s67, s67, 4096
    v_and_b32 v11, 15, v1
    s_add_u32 m0, s56, 141568
    s_nop 0
    buffer_load_dwordx4 v5, s[8:11], s51 offen offset:1792 lds
    v_lshlrev_b32 v11, 2, v11
    v_add_u32 v8, s67, v11
    s_lshl_b32 s68, s34, 2
    s_add_u32 s67, s67, s68
    s_add_u32 s67, s67, 32
    v_mov_b32 v7, s67
    s_add_u32 m0, s56, 12288
    s_nop 0
    buffer_load_dwordx4 v5, s[8:11], s51 offen offset:0 lds
    s_mov_b32 s57, 0
    s_mov_b32 s92, 0
    s_lshl_b32 s65, s35, 12
    s_add_u32 s62, s65, 98304
    v_add_u32 v179, s55, v2
    v_add_u32 v11, 0, v1
    s_add_u32 m0, s55, 49152
    s_nop 0
    buffer_load_dwordx4 v22, s[4:7], s40 offen lds
    v_mul_u32_u24 v12, 4682, v11
    v_lshrrev_b32 v12, 16, v12
    v_mul_u32_u24 v13, 14, v12
    v_sub_u32 v11, v11, v13
    v_mul_u32_u24 v12, 896, v12
    v_lshl_add_u32 v184, v11, 4, v12
    s_add_u32 m0, s55, 50176
    s_nop 0
    buffer_load_dwordx4 v23, s[4:7], s41 offen lds
    v_add_u32 v11, 64, v1
    v_mul_u32_u24 v12, 4682, v11
    v_lshrrev_b32 v12, 16, v12
    v_mul_u32_u24 v13, 14, v12
    v_sub_u32 v11, v11, v13
    v_mul_u32_u24 v12, 896, v12
    s_add_u32 m0, s55, 51200
    s_nop 0
    buffer_load_dwordx4 v22, s[4:7], s42 offen lds
    v_lshl_add_u32 v185, v11, 4, v12
    v_add_u32 v11, 128, v1
    v_mul_u32_u24 v12, 4682, v11
    v_lshrrev_b32 v12, 16, v12
    v_mul_u32_u24 v13, 14, v12
    v_sub_u32 v11, v11, v13
    s_add_u32 m0, s55, 52224
    s_nop 0
    buffer_load_dwordx4 v23, s[4:7], s43 offen lds
    s_waitcnt vmcnt(14)
    s_barrier
    v_mul_u32_u24 v12, 896, v12
    v_lshl_add_u32 v186, v11, 4, v12
    v_add_u32 v11, 192, v1
    v_mul_u32_u24 v12, 4682, v11
    v_lshrrev_b32 v12, 16, v12
    v_mul_u32_u24 v13, 14, v12
    s_add_u32 m0, s56, 44160
    s_nop 0
    buffer_load_dwordx4 v5, s[8:11], s52 offen offset:896 lds
    v_sub_u32 v11, v11, v13
    v_mul_u32_u24 v12, 896, v12
    v_lshl_add_u32 v187, v11, 4, v12
    v_add_u32 v11, 256, v1
    v_mul_u32_u24 v12, 4682, v11
    v_lshrrev_b32 v12, 16, v12
    s_add_u32 m0, s56, 145664
    s_nop 0
    buffer_load_dwordx4 v5, s[8:11], s52 offen offset:1792 lds
    v_mul_u32_u24 v13, 14, v12
    v_sub_u32 v11, v11, v13
    v_mul_u32_u24 v12, 896, v12
    v_lshl_add_u32 v188, v11, 4, v12
    v_add_u32 v11, 320, v1
    v_mul_u32_u24 v12, 4682, v11
    s_add_u32 m0, s56, 16384
    s_nop 0
    buffer_load_dwordx4 v5, s[8:11], s52 offen offset:0 lds
    v_lshrrev_b32 v12, 16, v12
    v_mul_u32_u24 v13, 14, v12
    v_sub_u32 v11, v11, v13
    v_mul_u32_u24 v12, 896, v12
    v_lshl_add_u32 v189, v11, 4, v12
    v_add_u32 v11, 384, v1
    s_add_u32 m0, s55, 0
    s_nop 0
    buffer_load_dwordx4 v24, s[4:7], s40 offen lds
    v_mul_u32_u24 v12, 4682, v11
    v_lshrrev_b32 v12, 16, v12
    v_mul_u32_u24 v13, 14, v12
    v_sub_u32 v11, v11, v13
    v_mul_u32_u24 v12, 896, v12
    v_lshl_add_u32 v190, v11, 4, v12
    s_add_u32 m0, s55, 1024
    s_nop 0
    buffer_load_dwordx4 v25, s[4:7], s41 offen lds
    v_bfe_u32 v12, v1, 4, 1
    v_lshrrev_b32 v13, 5, v1
    v_lshlrev_b32 v13, 4, v13
    v_lshl_add_u32 v13, v12, 2, v13
    v_bfe_u32 v12, v1, 2, 2
    v_add_u32 v13, v13, v12
    s_add_u32 m0, s55, 2048
    s_nop 0
    buffer_load_dwordx4 v24, s[4:7], s42 offen lds
    v_mul_u32_u24 v176, 224, v13
    v_and_b32 v12, 3, v1
    v_lshl_add_u32 v176, v12, 3, v176
    v_add_u32 v176, 63488, v176
    v_cmp_gt_u32 vcc, 48, v1
    v_add_u32 v177, 1792, v176
    s_add_u32 m0, s55, 3072
    s_nop 0
    buffer_load_dwordx4 v25, s[4:7], s43 offen lds
    s_waitcnt vmcnt(14)
    s_barrier
    v_add_u32 v178, 62720, v176
    v_cndmask_b32 v177, v176, v177, vcc
    v_add_u32 v191, 62720, v177
    s_lshl_b32 s68, s32, 3
    s_add_u32 s68, s68, s34
    s_lshl_b32 s68, s68, 2
    s_add_u32 m0, s56, 48256
    s_nop 0
    buffer_load_dwordx4 v5, s[8:11], s53 offen offset:896 lds
    s_add_u32 s68, s68, s91
    s_lshl_b32 s69, s68, 12
    s_add_u32 s69, s69, 65536
    v_and_b32 v11, 15, v1
    v_lshl_add_u32 v183, v11, 7, s69
    s_lshl_b32 s99, s68, 16
    s_add_u32 m0, s56, 149760
    s_nop 0
    buffer_load_dwordx4 v5, s[8:11], s53 offen offset:1792 lds
    v_bfe_u32 v12, v1, 4, 1
    v_lshrrev_b32 v13, 5, v1
    v_lshlrev_b32 v180, 4, v11
    v_lshl_add_u32 v180, v12, 9, v180
    v_lshl_add_u32 v180, v13, 10, v180
    s_lshr_b32 s69, s35, 1
    s_add_u32 m0, s56, 20480
    s_nop 0
    buffer_load_dwordx4 v5, s[8:11], s53 offen offset:0 lds
    s_lshl_b32 s69, s69, 11
    s_add_u32 s99, s99, s69
    s_and_b32 s69, s35, 1
    s_lshl_b32 s69, s69, 8
    s_add_u32 s99, s99, s69
    v_mul_u32_u24 v181, 1792, v11
    s_add_u32 m0, s55, 16384
    s_nop 0
    buffer_load_dwordx4 v26, s[4:7], s40 offen lds
    v_lshrrev_b32 v14, 4, v1
    v_lshl_add_u32 v182, v14, 3, v181
    v_lshl_add_u32 v181, v12, 5, v181
    v_lshl_add_u32 v181, v13, 4, v181
    s_lshl_b32 s98, s34, 2
    s_add_u32 s98, s98, s91
    s_add_u32 m0, s55, 17408
    s_nop 0
    buffer_load_dwordx4 v27, s[4:7], s41 offen lds
    s_lshl_b32 s98, s98, 2
    s_add_u32 s98, s98, s35
    s_mul_i32 s98, s98, 28672
    s_mul_i32 s69, s32, 896
    s_add_u32 s98, s98, s69
    s_mul_i32 s69, s90, 224
    s_add_u32 m0, s55, 18432
    s_nop 0
    buffer_load_dwordx4 v26, s[4:7], s42 offen lds
    s_add_u32 s98, s98, s69
    s_waitcnt lgkmcnt(0)
    s_mul_i32 s36, s36, 1664525
    s_add_u32 s36, s36, 1013904223
    v_mov_b32 v9, s36
    s_add_u32 m0, s55, 19456
    s_nop 0
    buffer_load_dwordx4 v27, s[4:7], s43 offen lds
    s_waitcnt vmcnt(14)
    s_barrier
    s_add_u32 m0, s56, 52352
    s_nop 0
    buffer_load_dwordx4 v5, s[8:11], s54 offen offset:896 lds
    s_add_u32 m0, s56, 153856
    s_nop 0
    buffer_load_dwordx4 v5, s[8:11], s54 offen offset:1792 lds
    s_add_u32 m0, s56, 24576
    s_nop 0
    buffer_load_dwordx4 v5, s[8:11], s54 offen offset:0 lds
    s_add_u32 m0, s55, 32768
    s_nop 0
    buffer_load_dwordx4 v28, s[4:7], s40 offen lds
    s_add_u32 m0, s55, 33792
    s_nop 0
    buffer_load_dwordx4 v29, s[4:7], s41 offen lds
    s_add_u32 m0, s55, 34816
    s_nop 0
    buffer_load_dwordx4 v28, s[4:7], s42 offen lds
    s_add_u32 m0, s55, 35840
    s_nop 0
    buffer_load_dwordx4 v29, s[4:7], s43 offen lds
    s_waitcnt vmcnt(14)
    s_barrier
    s_add_u32 m0, s55, 49152
    s_nop 0
    buffer_load_dwordx4 v16, s[4:7], s44 offen lds
    s_add_u32 m0, s55, 50176
    s_nop 0
    buffer_load_dwordx4 v17, s[4:7], s45 offen lds
    s_add_u32 m0, s55, 51200
    s_nop 0
    buffer_load_dwordx4 v16, s[4:7], s46 offen lds
    s_add_u32 m0, s55, 52224
    s_nop 0
    buffer_load_dwordx4 v17, s[4:7], s47 offen lds
    s_waitcnt vmcnt(11)
    s_barrier
    s_add_u32 m0, s55, 0
    s_nop 0
    buffer_load_dwordx4 v18, s[4:7], s44 offen lds
    s_add_u32 m0, s55, 1024
    s_nop 0
    buffer_load_dwordx4 v19, s[4:7], s45 offen lds
    s_add_u32 m0, s55, 2048
    s_nop 0
    buffer_load_dwordx4 v18, s[4:7], s46 offen lds
    s_add_u32 m0, s55, 3072
    s_nop 0
    buffer_load_dwordx4 v19, s[4:7], s47 offen lds
    s_waitcnt vmcnt(8)
    s_barrier
    s_add_u32 m0, s55, 16384
    s_nop 0
    buffer_load_dwordx4 v20, s[4:7], s44 offen lds
    s_add_u32 m0, s55, 17408
    s_nop 0
    buffer_load_dwordx4 v21, s[4:7], s45 offen lds
    s_add_u32 m0, s55, 18432
    s_nop 0
    buffer_load_dwordx4 v20, s[4:7], s46 offen lds
    s_add_u32 m0, s55, 19456
    s_nop 0
    buffer_load_dwordx4 v21, s[4:7], s47 offen lds
    s_waitcnt vmcnt(8)
    s_barrier
    s_add_u32 m0, s55, 32768
    s_nop 0
    buffer_load_dwordx4 v22, s[4:7], s44 offen lds
    s_add_u32 m0, s55, 33792
    s_nop 0
    buffer_load_dwordx4 v23, s[4:7], s45 offen lds
    s_add_u32 m0, s55, 34816
    s_nop 0
    buffer_load_dwordx4 v22, s[4:7], s46 offen lds
    s_add_u32 m0, s55, 35840
    s_nop 0
    buffer_load_dwordx4 v23, s[4:7], s47 offen lds
    s_waitcnt vmcnt(8)
    s_barrier
    s_add_u32 m0, s55, 49152
    s_nop 0
    buffer_load_dwordx4 v24, s[4:7], s44 offen lds
    s_add_u32 m0, s55, 50176
    s_nop 0
    buffer_load_dwordx4 v25, s[4:7], s45 offen lds
    s_add_u32 m0, s55, 51200
    s_nop 0
    buffer_load_dwordx4 v24, s[4:7], s46 offen lds
    s_add_u32 m0, s55, 52224
    s_nop 0
    buffer_load_dwordx4 v25, s[4:7], s47 offen lds
    s_waitcnt vmcnt(8)
    s_barrier
    s_add_u32 m0, s55, 0
    s_nop 0
    buffer_load_dwordx4 v26, s[4:7], s44 offen lds
    s_add_u32 m0, s55, 1024
    s_nop 0
    buffer_load_dwordx4 v27, s[4:7], s45 offen lds
    s_add_u32 m0, s55, 2048
    s_nop 0
    buffer_load_dwordx4 v26, s[4:7], s46 offen lds
    s_add_u32 m0, s55, 3072
    s_nop 0
    buffer_load_dwordx4 v27, s[4:7], s47 offen lds
    s_waitcnt vmcnt(8)
    s_barrier
    s_add_u32 m0, s55, 16384
    s_nop 0
    buffer_load_dwordx4 v28, s[4:7], s44 offen lds
    s_add_u32 m0, s55, 17408
    s_nop 0
    buffer_load_dwordx4 v29, s[4:7], s45 offen lds
    s_add_u32 m0, s55, 18432
    s_nop 0
    buffer_load_dwordx4 v28, s[4:7], s46 offen lds
    s_add_u32 m0, s55, 19456
    s_nop 0
    buffer_load_dwordx4 v29, s[4:7], s47 offen lds
L_touch0:
    s_mov_b64 exec, 0
    s_branch L_pad3
L_padret3:
    s_mov_b64 exec, -1
    s_waitcnt vmcnt(8)
    s_barrier
L_touch1:
    s_mov_b64 exec, 0
    s_branch L_pad4
L_padret4:
    s_mov_b64 exec, -1
    s_waitcnt vmcnt(4)
    s_barrier
L_touch2:
    s_mov_b64 exec, 0
    s_branch L_pad5
L_padret5:
    s_mov_b64 exec, -1
    s_waitcnt vmcnt(0)
    s_barrier
L_touch3:
    s_mov_b64 exec, 0
    s_branch L_pad6
L_padret6:
    s_mov_b64 exec, -1
    buffer_load_dword v10, v8, s[28:31], 0 offen sc1
    s_barrier
    ds_read_b128 v[44:47], v179 offset:16384
    ds_read_b128 v[48:51], v179 offset:17408
    ds_read_b128 v[52:55], v179 offset:18432
    ds_read_b128 v[56:59], v179 offset:19456
    s_waitcnt vmcnt(0)
    v_cmp_eq_u32 vcc, s36, v10
    s_nop 1
    s_mov_b32 s57, vcc_lo
    s_cmp_ge_u32 s92, 7
    s_cselect_b32 s68, 1, 0
    s_add_u32 s67, s34, s92
    s_add_u32 s67, s67, s68
    s_add_u32 s67, s67, 1
    s_and_b32 s67, s67, 7
    s_lshl_b32 s66, s67, 15
    s_lshl_b32 s69, s68, 12
    s_add_u32 s66, s66, s69
    s_lshl_b32 s68, s68, 3
    s_add_u32 s67, s67, s68
    s_bitcmp1_b32 s57, s67
    s_cbranch_scc1 L_rdy0
    s_mov_b32 s38, 0
L_poll0:
    buffer_load_dword v10, v8, s[28:31], 0 offen sc1
    s_add_u32 s38, s38, 1
    s_cmp_ge_u32 s38, 0x40000
    s_cbranch_scc1 L_rdy0
    s_waitcnt vmcnt(0)
    v_cmp_eq_u32 vcc, s36, v10
    s_nop 1
    s_mov_b32 s57, vcc_lo
    s_bitcmp1_b32 s57, s67
    s_cbranch_scc0 L_poll0
L_rdy0:
    s_add_u32 m0, s65, 0
    s_add_u32 s92, s92, 1
    buffer_load_dwordx4 v6, s[20:23], s66 offen offset:0 sc1 lds
    buffer_load_dwordx4 v6, s[20:23], s66 offen offset:1024 sc1 lds
    buffer_load_dwordx4 v6, s[20:23], s66 offen offset:2048 sc1 lds
    buffer_load_dwordx4 v6, s[20:23], s66 offen offset:3072 sc1 lds
    s_cmp_ge_u32 s92, 7
    s_cselect_b32 s68, 1, 0
    s_add_u32 s67, s34, s92
    s_add_u32 s67, s67, s68
L_pad0:
    s_cbranch_execz L_padret0
    s_add_u32 s67, s67, 1
    s_and_b32 s67, s67, 7
    s_lshl_b32 s66, s67, 15
    s_lshl_b32 s69, s68, 12
    s_add_u32 s66, s66, s69
    s_lshl_b32 s68, s68, 3
    s_add_u32 s67, s67, s68
    s_bitcmp1_b32 s57, s67
    s_cbranch_scc1 L_rdy1
    s_mov_b32 s38, 0
L_poll1:
    buffer_load_dword v10, v8, s[28:31], 0 offen sc1
    s_add_u32 s38, s38, 1
    s_cmp_ge_u32 s38, 0x40000
    s_cbranch_scc1 L_rdy1
    s_waitcnt vmcnt(0)
    v_cmp_eq_u32 vcc, s36, v10
    s_nop 1
    s_mov_b32 s57, vcc_lo
    s_bitcmp1_b32 s57, s67
    s_cbranch_scc0 L_poll1
L_rdy1:
    s_add_u32 m0, s65, 16384
    s_add_u32 s92, s92, 1
    buffer_load_dwordx4 v6, s[20:23], s66 offen offset:0 sc1 lds
    buffer_load_dwordx4 v6, s[20:23], s66 offen offset:1024 sc1 lds
    buffer_load_dwordx4 v6, s[20:23], s66 offen offset:2048 sc1 lds
    buffer_load_dwordx4 v6, s[20:23], s66 offen offset:3072 sc1 lds
    s_add_u32 s65, s65, 32768
    s_cmp_ge_u32 s65, s62
    s_cselect_b32 s67, 98304, 0
    s_sub_u32 s65, s65, s67
    s_setprio 0
    s_waitcnt lgkmcnt(0)
    buffer_store_dwordx4 v[44:47], v6, s[20:23], s86 offen offset:0 sc1
    buffer_store_dwordx4 v[48:51], v6, s[20:23], s86 offen offset:1024 sc1
    buffer_store_dwordx4 v[52:55], v6, s[20:23], s86 offen offset:2048 sc1
    buffer_store_dwordx4 v[56:59], v6, s[20:23], s86 offen offset:3072 sc1
    s_cmp_ge_u32 s92, 7
    s_cselect_b32 s68, 1, 0
    s_add_u32 s67, s34, s92
    s_add_u32 s67, s67, s68
    s_add_u32 s67, s67, 1
    s_and_b32 s67, s67, 7
    s_lshl_b32 s66, s67, 15
    s_lshl_b32 s69, s68, 12
    s_add_u32 s66, s66, s69
    s_lshl_b32 s68, s68, 3
    s_add_u32 s67, s67, s68
    s_bitcmp1_b32 s57, s67
    s_cbranch_scc1 L_rdy2
    s_mov_b32 s38, 0
L_poll2:
    buffer_load_dword v10, v8, s[28:31], 0 offen sc1
    s_add_u32 s38, s38, 1
    s_cmp_ge_u32 s38, 0x40000
    s_cbranch_scc1 L_rdy2
    s_waitcnt vmcnt(0)
    v_cmp_eq_u32 vcc, s36, v10
    s_nop 1
    s_mov_b32 s57, vcc_lo
    s_bitcmp1_b32 s57, s67
    s_cbranch_scc0 L_poll2
L_rdy2:
    s_add_u32 m0, s65, 0
    s_add_u32 s92, s92, 1
    buffer_load_dwordx4 v6, s[20:23], s66 offen offset:0 sc1 lds
    buffer_load_dwordx4 v6, s[20:23], s66 offen offset:1024 sc1 lds
    buffer_load_dwordx4 v6, s[20:23], s66 offen offset:2048 sc1 lds
    buffer_load_dwordx4 v6, s[20:23], s66 offen offset:3072 sc1 lds
    s_cmp_ge_u32 s92, 7
    s_cselect_b32 s68, 1, 0
    s_add_u32 s67, s34, s92
    s_add_u32 s67, s67, s68
    s_add_u32 s67, s67, 1
    s_and_b32 s67, s67, 7
    s_lshl_b32 s66, s67, 15
    s_lshl_b32 s69, s68, 12
    s_add_u32 s66, s66, s69
    s_lshl_b32 s68, s68, 3
    s_add_u32 s67, s67, s68
    s_bitcmp1_b32 s57, s67
    s_cbranch_scc1 L_rdy3
    s_mov_b32 s38, 0
L_poll3:
    buffer_load_dword v10, v8, s[28:31], 0 offen sc1
    s_add_u32 s38, s38, 1
    s_cmp_ge_u32 s38, 0x40000
    s_cbranch_scc1 L_rdy3
    s_waitcnt vmcnt(0)
    v_cmp_eq_u32 vcc, s36, v10
    s_nop 1
    s_mov_b32 s57, vcc_lo
    s_bitcmp1_b32 s57, s67
    s_cbranch_scc0 L_poll3
L_rdy3:
    s_add_u32 m0, s65, 16384
    s_add_u32 s92, s92, 1
    buffer_load_dwordx4 v6, s[20:23], s66 offen offset:0 sc1 lds
    buffer_load_dwordx4 v6, s[20:23], s66 offen offset:1024 sc1 lds
    buffer_load_dwordx4 v6, s[20:23], s66 offen offset:2048 sc1 lds
    buffer_load_dwordx4 v6, s[20:23], s66 offen offset:3072 sc1 lds
    s_add_u32 s65, s65, 32768
    s_cmp_ge_u32 s65, s62
    s_cselect_b32 s67, 98304, 0
    s_sub_u32 s65, s65, s67
    s_waitcnt vmcnt(12)
    s_barrier
    s_waitcnt vmcnt(8)
    buffer_store_dword v9, v7, s[28:31], 0 offen sc1
    s_cmp_ge_u32 s92, 7
    s_cselect_b32 s68, 1, 0
    s_add_u32 s67, s34, s92
    s_add_u32 s67, s67, s68
    s_add_u32 s67, s67, 1
    s_and_b32 s67, s67, 7
    s_lshl_b32 s66, s67, 15
    s_lshl_b32 s69, s68, 12
    s_add_u32 s66, s66, s69
    s_lshl_b32 s68, s68, 3
    s_add_u32 s67, s67, s68
    s_bitcmp1_b32 s57, s67
    s_cbranch_scc1 L_rdy4
    s_mov_b32 s38, 0
L_poll4:
    buffer_load_dword v10, v8, s[28:31], 0 offen sc1
    s_add_u32 s38, s38, 1
    s_cmp_ge_u32 s38, 0x40000
    s_cbranch_scc1 L_rdy4
    s_waitcnt vmcnt(0)
    v_cmp_eq_u32 vcc, s36, v10
    s_nop 1
    s_mov_b32 s57, vcc_lo
    s_bitcmp1_b32 s57, s67
    s_cbranch_scc0 L_poll4
L_rdy4:
    s_add_u32 m0, s65, 0
    s_add_u32 s92, s92, 1
    buffer_load_dwordx4 v6, s[20:23], s66 offen offset:0 sc1 lds
    buffer_load_dwordx4 v6, s[20:23], s66 offen offset:1024 sc1 lds
    buffer_load_dwordx4 v6, s[20:23], s66 offen offset:2048 sc1 lds
    buffer_load_dwordx4 v6, s[20:23], s66 offen offset:3072 sc1 lds
    s_cmp_ge_u32 s92, 7
    s_cselect_b32 s68, 1, 0
    s_add_u32 s67, s34, s92
    s_add_u32 s67, s67, s68
    s_add_u32 s67, s67, 1
    s_and_b32 s67, s67, 7
    s_lshl_b32 s66, s67, 15
    s_lshl_b32 s69, s68, 12
    s_add_u32 s66, s66, s69
    s_lshl_b32 s68, s68, 3
    s_add_u32 s67, s67, s68
    s_bitcmp1_b32 s57, s67
    s_cbranch_scc1 L_rdy5
    s_mov_b32 s38, 0
L_poll5:
    buffer_load_dword v10, v8, s[28:31], 0 offen sc1
    s_add_u32 s38, s38, 1
    s_cmp_ge_u32 s38, 0x40000
    s_cbranch_scc1 L_rdy5
    s_waitcnt vmcnt(0)
    v_cmp_eq_u32 vcc, s36, v10
    s_nop 1
    s_mov_b32 s57, vcc_lo
    s_bitcmp1_b32 s57, s67
    s_cbranch_scc0 L_poll5
L_rdy5:
    s_add_u32 m0, s65, 16384
    s_add_u32 s92, s92, 1
    buffer_load_dwordx4 v6, s[20:23], s66 offen offset:0 sc1 lds
    buffer_load_dwordx4 v6, s[20:23], s66 offen offset:1024 sc1 lds
    buffer_load_dwordx4 v6, s[20:23], s66 offen offset:2048 sc1 lds
    buffer_load_dwordx4 v6, s[20:23], s66 offen offset:3072 sc1 lds
    s_add_u32 s65, s65, 32768
    s_cmp_ge_u32 s65, s62
    s_cselect_b32 s67, 98304, 0
    s_sub_u32 s65, s65, s67
    s_and_b32 s67, s35, 3
    s_add_u32 s67, s67, 10
    s_mul_i32 s89, s67, 7168
    s_add_u32 s89, s89, 63488
    s_mul_i32 s88, s67, 28672
    s_mul_i32 s67, s90, 224
    s_add_u32 s88, s88, s67
    s_add_u32 m0, s89, 0
    s_nop 0
    buffer_load_dwordx4 v184, s[12:15], s88 offen lds
    s_add_u32 m0, s89, 1024
    s_nop 0
    buffer_load_dwordx4 v185, s[12:15], s88 offen lds
    s_add_u32 m0, s89, 2048
    s_nop 0
    buffer_load_dwordx4 v186, s[12:15], s88 offen lds
    s_add_u32 m0, s89, 3072
    s_nop 0
    buffer_load_dwordx4 v187, s[12:15], s88 offen lds
    s_add_u32 m0, s89, 4096
    s_nop 0
    buffer_load_dwordx4 v188, s[12:15], s88 offen lds
    s_add_u32 m0, s89, 5120
    s_nop 0
    buffer_load_dwordx4 v189, s[12:15], s88 offen lds
    s_add_u32 m0, s89, 6144
    s_nop 0
    buffer_load_dwordx4 v190, s[12:15], s88 offen lds
    s_waitcnt vmcnt(16)
    s_barrier
    s_cmp_ge_u32 s92, 7
    s_cselect_b32 s68, 1, 0
    s_add_u32 s67, s34, s92
    s_add_u32 s67, s67, s68
    s_add_u32 s67, s67, 1
    s_and_b32 s67, s67, 7
    s_lshl_b32 s66, s67, 15
    s_lshl_b32 s69, s68, 12
    s_add_u32 s66, s66, s69
    s_lshl_b32 s68, s68, 3
    s_add_u32 s67, s67, s68
    s_bitcmp1_b32 s57, s67
    s_cbranch_scc1 L_rdy6
    s_mov_b32 s38, 0
L_poll6:
    buffer_load_dword v10, v8, s[28:31], 0 offen sc1
    s_add_u32 s38, s38, 1
    s_cmp_ge_u32 s38, 0x40000
    s_cbranch_scc1 L_rdy6
    s_waitcnt vmcnt(0)
    v_cmp_eq_u32 vcc, s36, v10
    s_nop 1
    s_mov_b32 s57, vcc_lo
    s_bitcmp1_b32 s57, s67
    s_cbranch_scc0 L_poll6
L_rdy6:
    s_add_u32 m0, s65, 0
    s_add_u32 s92, s92, 1
    buffer_load_dwordx4 v6, s[20:23], s66 offen offset:0 sc1 lds
    buffer_load_dwordx4 v6, s[20:23], s66 offen offset:1024 sc1 lds
    buffer_load_dwordx4 v6, s[20:23], s66 offen offset:2048 sc1 lds
    buffer_load_dwordx4 v6, s[20:23], s66 offen offset:3072 sc1 lds
    s_cmp_ge_u32 s92, 7
    s_cselect_b32 s68, 1, 0
    s_add_u32 s67, s34, s92
    s_add_u32 s67, s67, s68
    s_add_u32 s67, s67, 1
    s_and_b32 s67, s67, 7
    s_lshl_b32 s66, s67, 15
    s_lshl_b32 s69, s68, 12
    s_add_u32 s66, s66, s69
    s_lshl_b32 s68, s68, 3
    s_add_u32 s67, s67, s68
    s_bitcmp1_b32 s57, s67
    s_cbranch_scc1 L_rdy7
    s_mov_b32 s38, 0
L_poll7:
    buffer_load_dword v10, v8, s[28:31], 0 offen sc1
    s_add_u32 s38, s38, 1
    s_cmp_ge_u32 s38, 0x40000
    s_cbranch_scc1 L_rdy7
    s_waitcnt vmcnt(0)
    v_cmp_eq_u32 vcc, s36, v10
    s_nop 1
    s_mov_b32 s57, vcc_lo
    s_bitcmp1_b32 s57, s67
    s_cbranch_scc0 L_poll7
L_rdy7:
    s_add_u32 m0, s65, 16384
    s_add_u32 s92, s92, 1
    buffer_load_dwordx4 v6, s[20:23], s66 offen offset:0 sc1 lds
    buffer_load_dwordx4 v6, s[20:23], s66 offen offset:1024 sc1 lds
    buffer_load_dwordx4 v6, s[20:23], s66 offen offset:2048 sc1 lds
    buffer_load_dwordx4 v6, s[20:23], s66 offen offset:3072 sc1 lds
    s_add_u32 s65, s65, 32768
    s_cmp_ge_u32 s65, s62
    s_cselect_b32 s67, 98304, 0
    s_sub_u32 s65, s65, s67
    s_and_b32 s67, s35, 3
    s_add_u32 s67, s67, 6
    s_mul_i32 s89, s67, 7168
    s_add_u32 s89, s89, 63488
    s_mul_i32 s88, s67, 28672
    s_mul_i32 s67, s90, 224
    s_add_u32 s88, s88, s67
    s_add_u32 m0, s89, 0
    s_nop 0
    buffer_load_dwordx4 v184, s[12:15], s88 offen lds
    s_add_u32 m0, s89, 1024
    s_nop 0
    buffer_load_dwordx4 v185, s[12:15], s88 offen lds
    s_add_u32 m0, s89, 2048
    s_nop 0
    buffer_load_dwordx4 v186, s[12:15], s88 offen lds
    s_add_u32 m0, s89, 3072
    s_nop 0
    buffer_load_dwordx4 v187, s[12:15], s88 offen lds
    s_add_u32 m0, s89, 4096
    s_nop 0
    buffer_load_dwordx4 v188, s[12:15], s88 offen lds
    s_add_u32 m0, s89, 5120
    s_nop 0
    buffer_load_dwordx4 v189, s[12:15], s88 offen lds
    s_add_u32 m0, s89, 6144
    s_nop 0
    buffer_load_dwordx4 v190, s[12:15], s88 offen lds
    s_and_b32 s69, s99, 0xfffc0000
    s_lshl_b32 s68, s35, 16
    s_lshl_b32 s67, s33, 12
    s_add_u32 s69, s69, s68
    s_add_u32 s69, s69, s67
    v_mov_b32 v11, 0
    buffer_load_dword v44, v11, s[16:19], s98 offen
    buffer_load_dword v45, v11, s[24:27], s69 offen sc1
    s_waitcnt vmcnt(24)
    s_barrier
    s_cmp_ge_u32 s92, 7
    s_cselect_b32 s68, 1, 0
    s_add_u32 s67, s34, s92
    s_add_u32 s67, s67, s68
    s_add_u32 s67, s67, 1
    s_and_b32 s67, s67, 7
    s_lshl_b32 s66, s67, 15
    s_lshl_b32 s69, s68, 12
    s_add_u32 s66, s66, s69
    s_lshl_b32 s68, s68, 3
    s_add_u32 s67, s67, s68
    s_bitcmp1_b32 s57, s67
    s_cbranch_scc1 L_rdy8
    s_mov_b32 s38, 0
L_poll8:
    buffer_load_dword v10, v8, s[28:31], 0 offen sc1
    s_add_u32 s38, s38, 1
    s_cmp_ge_u32 s38, 0x40000
    s_cbranch_scc1 L_rdy8
    s_waitcnt vmcnt(0)
    v_cmp_eq_u32 vcc, s36, v10
    s_nop 1
    s_mov_b32 s57, vcc_lo
    s_bitcmp1_b32 s57, s67
    s_cbranch_scc0 L_poll8
L_rdy8:
    s_add_u32 m0, s65, 0
    s_add_u32 s92, s92, 1
    buffer_load_dwordx4 v6, s[20:23], s66 offen offset:0 sc1 lds
    buffer_load_dwordx4 v6, s[20:23], s66 offen offset:1024 sc1 lds
    buffer_load_dwordx4 v6, s[20:23], s66 offen offset:2048 sc1 lds
    buffer_load_dwordx4 v6, s[20:23], s66 offen offset:3072 sc1 lds
    s_cmp_ge_u32 s92, 7
    s_cselect_b32 s68, 1, 0
    s_add_u32 s67, s34, s92
    s_add_u32 s67, s67, s68
    s_add_u32 s67, s67, 1
    s_and_b32 s67, s67, 7
    s_lshl_b32 s66, s67, 15
    s_lshl_b32 s69, s68, 12
    s_add_u32 s66, s66, s69
    s_lshl_b32 s68, s68, 3
    s_add_u32 s67, s67, s68
    s_bitcmp1_b32 s57, s67
    s_cbranch_scc1 L_rdy9
    s_mov_b32 s38, 0
L_poll9:
    buffer_load_dword v10, v8, s[28:31], 0 offen sc1
    s_add_u32 s38, s38, 1
    s_cmp_ge_u32 s38, 0x40000
    s_cbranch_scc1 L_rdy9
    s_waitcnt vmcnt(0)
    v_cmp_eq_u32 vcc, s36, v10
    s_nop 1
    s_mov_b32 s57, vcc_lo
    s_bitcmp1_b32 s57, s67
    s_cbranch_scc0 L_poll9
L_rdy9:
    s_add_u32 m0, s65, 16384
    s_add_u32 s92, s92, 1
    buffer_load_dwordx4 v6, s[20:23], s66 offen offset:0 sc1 lds
    buffer_load_dwordx4 v6, s[20:23], s66 offen offset:1024 sc1 lds
    buffer_load_dwordx4 v6, s[20:23], s66 offen offset:2048 sc1 lds
    buffer_load_dwordx4 v6, s[20:23], s66 offen offset:3072 sc1 lds
    s_add_u32 s65, s65, 32768
    s_cmp_ge_u32 s65, s62
    s_cselect_b32 s67, 98304, 0
    s_sub_u32 s65, s65, s67
    s_waitcnt vmcnt(17)
    s_barrier
    s_cmp_ge_u32 s92, 7
    s_cselect_b32 s68, 1, 0
    s_add_u32 s67, s34, s92
    s_add_u32 s67, s67, s68
    s_add_u32 s67, s67, 1
    s_and_b32 s67, s67, 7
    s_lshl_b32 s66, s67, 15
    s_lshl_b32 s69, s68, 12
    s_add_u32 s66, s66, s69
    s_lshl_b32 s68, s68, 3
    s_add_u32 s67, s67, s68
    s_bitcmp1_b32 s57, s67
    s_cbranch_scc1 L_rdy10
    s_mov_b32 s38, 0
L_poll10:
    buffer_load_dword v10, v8, s[28:31], 0 offen sc1
    s_add_u32 s38, s38, 1
    s_cmp_ge_u32 s38, 0x40000
    s_cbranch_scc1 L_rdy10
    s_waitcnt vmcnt(0)
    v_cmp_eq_u32 vcc, s36, v10
    s_nop 1
    s_mov_b32 s57, vcc_lo
    s_bitcmp1_b32 s57, s67
    s_cbranch_scc0 L_poll10
L_rdy10:
    s_add_u32 m0, s65, 0
    s_add_u32 s92, s92, 1
    buffer_load_dwordx4 v6, s[20:23], s66 offen offset:0 sc1 lds
    buffer_load_dwordx4 v6, s[20:23], s66 offen offset:1024 sc1 lds
    buffer_load_dwordx4 v6, s[20:23], s66 offen offset:2048 sc1 lds
    buffer_load_dwordx4 v6, s[20:23], s66 offen offset:3072 sc1 lds
    s_cmp_ge_u32 s92, 7
    s_cselect_b32 s68, 1, 0
    s_add_u32 s67, s34, s92
    s_add_u32 s67, s67, s68
    s_add_u32 s67, s67, 1
    s_and_b32 s67, s67, 7
    s_lshl_b32 s66, s67, 15
    s_lshl_b32 s69, s68, 12
    s_add_u32 s66, s66, s69
    s_lshl_b32 s68, s68, 3
    s_add_u32 s67, s67, s68
    s_bitcmp1_b32 s57, s67
    s_cbranch_scc1 L_rdy11
    s_mov_b32 s38, 0
L_poll11:
    buffer_load_dword v10, v8, s[28:31], 0 offen sc1
    s_add_u32 s38, s38, 1
    s_cmp_ge_u32 s38, 0x40000
    s_cbranch_scc1 L_rdy11
    s_waitcnt vmcnt(0)
    v_cmp_eq_u32 vcc, s36, v10
    s_nop 1
    s_mov_b32 s57, vcc_lo
    s_bitcmp1_b32 s57, s67
    s_cbranch_scc0 L_poll11
L_rdy11:
    s_add_u32 m0, s65, 16384
    s_add_u32 s92, s92, 1
    buffer_load_dwordx4 v6, s[20:23], s66 offen offset:0 sc1 lds
    buffer_load_dwordx4 v6, s[20:23], s66 offen offset:1024 sc1 lds
    buffer_load_dwordx4 v6, s[20:23], s66 offen offset:2048 sc1 lds
    buffer_load_dwordx4 v6, s[20:23], s66 offen offset:3072 sc1 lds
    s_add_u32 s65, s65, 32768
    s_cmp_ge_u32 s65, s62
    s_cselect_b32 s67, 98304, 0
    s_sub_u32 s65, s65, s67
    s_waitcnt vmcnt(8)
    s_barrier
    s_cmp_ge_u32 s92, 7
    s_cselect_b32 s68, 1, 0
    s_add_u32 s67, s34, s92
    s_add_u32 s67, s67, s68
    s_add_u32 s67, s67, 1
    s_and_b32 s67, s67, 7
    s_lshl_b32 s66, s67, 15
    s_lshl_b32 s69, s68, 12
    s_add_u32 s66, s66, s69
    s_lshl_b32 s68, s68, 3
    s_add_u32 s67, s67, s68
    s_bitcmp1_b32 s57, s67
    s_cbranch_scc1 L_rdy12
    s_mov_b32 s38, 0
L_poll12:
    buffer_load_dword v10, v8, s[28:31], 0 offen sc1
    s_add_u32 s38, s38, 1
    s_cmp_ge_u32 s38, 0x40000
    s_cbranch_scc1 L_rdy12
    s_waitcnt vmcnt(0)
    v_cmp_eq_u32 vcc, s36, v10
    s_nop 1
    s_mov_b32 s57, vcc_lo
    s_bitcmp1_b32 s57, s67
    s_cbranch_scc0 L_poll12
L_rdy12:
    s_add_u32 m0, s65, 0
    s_add_u32 s92, s92, 1
    buffer_load_dwordx4 v6, s[20:23], s66 offen offset:0 sc1 lds
    buffer_load_dwordx4 v6, s[20:23], s66 offen offset:1024 sc1 lds
    buffer_load_dwordx4 v6, s[20:23], s66 offen offset:2048 sc1 lds
    buffer_load_dwordx4 v6, s[20:23], s66 offen offset:3072 sc1 lds
    s_cmp_ge_u32 s92, 7
    s_cselect_b32 s68, 1, 0
    s_add_u32 s67, s34, s92
    s_add_u32 s67, s67, s68
    s_add_u32 s67, s67, 1
    s_and_b32 s67, s67, 7
    s_lshl_b32 s66, s67, 15
    s_lshl_b32 s69, s68, 12
    s_add_u32 s66, s66, s69
    s_lshl_b32 s68, s68, 3
    s_add_u32 s67, s67, s68
    s_bitcmp1_b32 s57, s67
    s_cbranch_scc1 L_rdy13
    s_mov_b32 s38, 0
L_poll13:
    buffer_load_dword v10, v8, s[28:31], 0 offen sc1
    s_add_u32 s38, s38, 1
    s_cmp_ge_u32 s38, 0x40000
    s_cbranch_scc1 L_rdy13
    s_waitcnt vmcnt(0)
    v_cmp_eq_u32 vcc, s36, v10
    s_nop 1
    s_mov_b32 s57, vcc_lo
    s_bitcmp1_b32 s57, s67
    s_cbranch_scc0 L_poll13
L_rdy13:
    s_add_u32 m0, s65, 16384
    s_add_u32 s92, s92, 1
    buffer_load_dwordx4 v6, s[20:23], s66 offen offset:0 sc1 lds
    buffer_load_dwordx4 v6, s[20:23], s66 offen offset:1024 sc1 lds
    buffer_load_dwordx4 v6, s[20:23], s66 offen offset:2048 sc1 lds
    buffer_load_dwordx4 v6, s[20:23], s66 offen offset:3072 sc1 lds
    s_add_u32 s65, s65, 32768
    s_cmp_ge_u32 s65, s62
    s_cselect_b32 s67, 98304, 0
    s_sub_u32 s65, s65, s67
    s_waitcnt vmcnt(8)
    s_barrier
    v_not_b32 v12, v9
    v_mov_b32 v13, v12
    v_mov_b32 v7, 32768
    ds_write_b64 v7, v[12:13]
    s_waitcnt lgkmcnt(0)
    s_waitcnt vmcnt(0)
    s_barrier
    s_and_b32 s67, s35, 3
    s_add_u32 s67, s67, 0
    s_mul_i32 s89, s67, 7168
    s_add_u32 s89, s89, 63488
    s_mul_i32 s88, s67, 28672
    s_mul_i32 s67, s90, 224
    s_add_u32 s88, s88, s67
    s_add_u32 m0, s89, 0
    s_nop 0
    buffer_load_dwordx4 v184, s[12:15], s88 offen lds
    s_add_u32 m0, s89, 1024
    s_nop 0
    buffer_load_dwordx4 v185, s[12:15], s88 offen lds
    s_add_u32 m0, s89, 2048
    s_nop 0
    buffer_load_dwordx4 v186, s[12:15], s88 offen lds
    s_add_u32 m0, s89, 3072
    s_nop 0
    buffer_load_dwordx4 v187, s[12:15], s88 offen lds
    s_add_u32 m0, s89, 4096
    s_nop 0
    buffer_load_dwordx4 v188, s[12:15], s88 offen lds
    s_add_u32 m0, s89, 5120
    s_nop 0
    buffer_load_dwordx4 v189, s[12:15], s88 offen lds
    s_add_u32 m0, s89, 6144
    s_nop 0
    buffer_load_dwordx4 v190, s[12:15], s88 offen lds
    s_and_b32 s67, s35, 1
    s_add_u32 s67, s67, 4
    s_mul_i32 s89, s67, 7168
    s_add_u32 s89, s89, 63488
    s_mul_i32 s88, s67, 28672
    s_mul_i32 s67, s90, 224
    s_add_u32 s88, s88, s67
    s_add_u32 m0, s89, 0
    s_nop 0
    buffer_load_dwordx4 v184, s[12:15], s88 offen lds
    s_add_u32 m0, s89, 1024
    s_nop 0
    buffer_load_dwordx4 v185, s[12:15], s88 offen lds
    s_add_u32 m0, s89, 2048
    s_nop 0
    buffer_load_dwordx4 v186, s[12:15], s88 offen lds
    s_add_u32 m0, s89, 3072
    s_nop 0
    buffer_load_dwordx4 v187, s[12:15], s88 offen lds
    s_add_u32 m0, s89, 4096
    s_nop 0
    buffer_load_dwordx4 v188, s[12:15], s88 offen lds
    s_add_u32 m0, s89, 5120
    s_nop 0
    buffer_load_dwordx4 v189, s[12:15], s88 offen lds
    s_add_u32 m0, s89, 6144
    s_nop 0
    buffer_load_dwordx4 v190, s[12:15], s88 offen lds
    s_waitcnt vmcnt(0)
    s_barrier
    s_cmp_lg_u32 s35, 0
    s_cbranch_scc1 L_nopeek
    buffer_load_dword v10, v183, s[28:31], 0 offen sc1
L_nopeek:
    ds_read_b64_tr_b16 a[0:1], v176 offset:0
    ds_read_b64_tr_b16 a[2:3], v177 offset:0
    ds_read_b64_tr_b16 a[4:5], v176 offset:32
    ds_read_b64_tr_b16 a[6:7], v177 offset:32
    ds_read_b64_tr_b16 a[8:9], v176 offset:64
    ds_read_b64_tr_b16 a[10:11], v177 offset:64
    ds_read_b64_tr_b16 a[12:13], v176 offset:96
    ds_read_b64_tr_b16 a[14:15], v177 offset:96
    ds_read_b64_tr_b16 a[16:17], v176 offset:128
    ds_read_b64_tr_b16 a[18:19], v177 offset:128
    ds_read_b64_tr_b16 a[20:21], v176 offset:160
    ds_read_b64_tr_b16 a[22:23], v177 offset:160
    s_waitcnt lgkmcnt(2)
    ds_read_b64_tr_b16 a[24:25], v176 offset:192
    ds_read_b64_tr_b16 a[26:27], v177 offset:192
    ds_read_b64_tr_b16 a[28:29], v176 offset:6272
    ds_read_b64_tr_b16 a[30:31], v177 offset:6272
    ds_read_b64_tr_b16 a[32:33], v176 offset:6304
    ds_read_b64_tr_b16 a[34:35], v177 offset:6304
    ds_read_b64_tr_b16 a[36:37], v176 offset:6336
    ds_read_b64_tr_b16 a[38:39], v177 offset:6336
    ds_read_b64_tr_b16 a[40:41], v176 offset:6368
    ds_read_b64_tr_b16 a[42:43], v177 offset:6368
    ds_read_b64_tr_b16 a[44:45], v176 offset:6400
    ds_read_b64_tr_b16 a[46:47], v177 offset:6400
    s_waitcnt lgkmcnt(2)
    ds_read_b64_tr_b16 a[48:49], v176 offset:6432
    ds_read_b64_tr_b16 a[50:51], v177 offset:6432
    ds_read_b64_tr_b16 a[52:53], v176 offset:6464
    ds_read_b64_tr_b16 a[54:55], v177 offset:6464
    ds_read_b64_tr_b16 a[56:57], v176 offset:18816
    ds_read_b64_tr_b16 a[58:59], v177 offset:18816
    ds_read_b64_tr_b16 a[60:61], v176 offset:18848
    ds_read_b64_tr_b16 a[62:63], v177 offset:18848
    ds_read_b64_tr_b16 v[108:109], v176 offset:18880
    ds_read_b64_tr_b16 v[110:111], v177 offset:18880
    ds_read_b64_tr_b16 v[112:113], v176 offset:18912
    ds_read_b64_tr_b16 v[114:115], v177 offset:18912
    s_waitcnt lgkmcnt(2)
    ds_read_b64_tr_b16 v[116:117], v176 offset:18944
    ds_read_b64_tr_b16 v[118:119], v177 offset:18944
    ds_read_b64_tr_b16 v[120:121], v176 offset:18976
    ds_read_b64_tr_b16 v[122:123], v177 offset:18976
    ds_read_b64_tr_b16 v[124:125], v176 offset:19008
    ds_read_b64_tr_b16 v[126:127], v177 offset:19008
    ds_read_b64_tr_b16 v[128:129], v176 offset:31360
    ds_read_b64_tr_b16 v[130:131], v177 offset:31360
    ds_read_b64_tr_b16 v[132:133], v176 offset:31392
    ds_read_b64_tr_b16 v[134:135], v177 offset:31392
    ds_read_b64_tr_b16 v[136:137], v176 offset:31424
    ds_read_b64_tr_b16 v[138:139], v177 offset:31424
    s_waitcnt lgkmcnt(2)
    ds_read_b64_tr_b16 v[140:141], v176 offset:31456
    ds_read_b64_tr_b16 v[142:143], v177 offset:31456
    ds_read_b64_tr_b16 v[144:145], v176 offset:31488
    ds_read_b64_tr_b16 v[146:147], v177 offset:31488
    ds_read_b64_tr_b16 v[148:149], v176 offset:31520
    ds_read_b64_tr_b16 v[150:151], v177 offset:31520
    ds_read_b64_tr_b16 v[152:153], v176 offset:31552
    ds_read_b64_tr_b16 v[154:155], v177 offset:31552
    ds_read_b64_tr_b16 v[156:157], v176 offset:43904
    ds_read_b64_tr_b16 v[158:159], v177 offset:43904
    ds_read_b64_tr_b16 v[160:161], v176 offset:43936
    ds_read_b64_tr_b16 v[162:163], v177 offset:43936
    s_waitcnt lgkmcnt(2)
    ds_read_b64_tr_b16 v[164:165], v176 offset:43968
    ds_read_b64_tr_b16 v[166:167], v177 offset:43968
    ds_read_b64_tr_b16 v[168:169], v176 offset:44000
    ds_read_b64_tr_b16 v[170:171], v177 offset:44000
    s_mul_i32 s67, s35, 3840
    v_add_u32 v11, 0, v1
    v_mul_u32_u24 v12, 4682, v11
    v_lshrrev_b32 v12, 16, v12
    v_mul_u32_u24 v13, 14, v12
    v_sub_u32 v11, v11, v13
    v_lshlrev_b32 v11, 4, v11
    v_mul_u32_u24 v13, 240, v12
    v_add3_u32 v184, v13, v11, s67
    v_mul_u32_u24 v12, 1792, v12
    v_add_u32 v172, v12, v11
    v_add_u32 v11, 64, v1
    v_mul_u32_u24 v12, 4682, v11
    v_lshrrev_b32 v12, 16, v12
    v_mul_u32_u24 v13, 14, v12
    v_sub_u32 v11, v11, v13
    v_lshlrev_b32 v11, 4, v11
    v_mul_u32_u24 v13, 240, v12
    v_add3_u32 v185, v13, v11, s67
    v_mul_u32_u24 v12, 1792, v12
    v_add_u32 v173, v12, v11
    v_add_u32 v11, 128, v1
    v_mul_u32_u24 v12, 4682, v11
    v_lshrrev_b32 v12, 16, v12
    v_mul_u32_u24 v13, 14, v12
    v_sub_u32 v11, v11, v13
    v_lshlrev_b32 v11, 4, v11
    v_mul_u32_u24 v13, 240, v12
    v_add3_u32 v186, v13, v11, s67
    v_mul_u32_u24 v12, 1792, v12
    v_add_u32 v174, v12, v11
    v_add_u32 v11, 192, v1
    v_mul_u32_u24 v12, 4682, v11
    v_lshrrev_b32 v12, 16, v12
    v_mul_u32_u24 v13, 14, v12
    v_sub_u32 v11, v11, v13
    v_lshlrev_b32 v11, 4, v11
    v_mul_u32_u24 v13, 240, v12
    v_add3_u32 v187, v13, v11, s67
    v_mul_u32_u24 v12, 1792, v12
    v_add_u32 v175, v12, v11
    v_cmp_gt_u32 vcc, 32, v1
    v_mov_b32 v11, 0x7000000
    v_and_b32 v12, 15, v1
    v_cndmask_b32 v175, v11, v175, vcc
    v_mul_u32_u24 v12, 240, v12
    v_add_u32 v12, s67, v12
    v_lshrrev_b32 v13, 4, v1
    v_lshl_add_u32 v189, v13, 3, v12
    v_bfe_u32 v11, v1, 4, 1
    v_lshrrev_b32 v13, 5, v1
    v_lshl_add_u32 v12, v11, 5, v12
    v_lshl_add_u32 v188, v13, 4, v12
    s_cmp_lg_u32 s35, 0
    s_cbranch_scc1 L_nopeek2
    s_waitcnt vmcnt(0)
    v_cmp_ne_u32 vcc, s36, v10
    s_nop 1
    s_and_b32 s67, vcc_lo, 54699
    s_cbranch_scc0 L_peekok
    buffer_load_dword v10, v183, s[28:31], 0 offen sc1
    s_waitcnt vmcnt(0)
    v_cmp_ne_u32 vcc, s36, v10
    s_nop 1
    s_and_b32 s67, vcc_lo, 54699
    s_cbranch_scc1 L_nopeek2
L_peekok:
    ds_write_b32 v7, v9
L_nopeek2:
    s_mov_b32 s38, 0
L_spin0:
    ds_read_b32 v12, v7 offset:0
    s_add_u32 s38, s38, 1
    s_cmp_ge_u32 s38, 0x1000000
    s_waitcnt lgkmcnt(0)
    s_cbranch_scc1 L_spin0_ok
    v_cmp_ne_u32 vcc, s36, v12
    s_nop 1
    s_cbranch_vccz L_spin0_ok
    s_sleep 1
    s_branch L_spin0
L_spin0_ok:
    ds_read_b32 v12, v7 offset:4
    s_mov_b32 s57, 0
    s_add_u32 s68, s99, 0
    buffer_load_dwordx4 v[44:47], v180, s[24:27], s68 offen sc1
    s_add_u32 s68, s99, 4096
    buffer_load_dwordx4 v[48:51], v180, s[24:27], s68 offen sc1
    s_add_u32 s68, s99, 12288
    buffer_load_dwordx4 v[52:55], v180, s[24:27], s68 offen sc1
    s_add_u32 s68, s99, 20480
    buffer_load_dwordx4 v[56:59], v180, s[24:27], s68 offen sc1
    s_add_u32 s68, s99, 28672
    buffer_load_dwordx4 v[60:63], v180, s[24:27], s68 offen sc1
    s_add_u32 s68, s99, 32768
    buffer_load_dwordx4 v[64:67], v180, s[24:27], s68 offen sc1
    s_add_u32 s68, s99, 40960
    buffer_load_dwordx4 v[68:71], v180, s[24:27], s68 offen sc1
    s_add_u32 s68, s99, 49152
    buffer_load_dwordx4 v[72:75], v180, s[24:27], s68 offen sc1
    s_add_u32 s68, s99, 57344
    buffer_load_dwordx4 v[76:79], v180, s[24:27], s68 offen sc1
L_pad1:
    s_cbranch_execz L_padret1
    s_add_u32 s68, s99, 61440
    buffer_load_dwordx4 v[80:83], v180, s[24:27], s68 offen sc1
    s_waitcnt lgkmcnt(0)
    v_cmp_ne_u32 vcc, s36, v12
    s_nop 1
    s_cbranch_vccnz L_later
    s_mov_b32 s57, 1
    s_add_u32 s68, s99, 8192
    buffer_load_dwordx4 v[84:87], v180, s[24:27], s68 offen sc1
    s_add_u32 s68, s99, 16384
    buffer_load_dwordx4 v[88:91], v180, s[24:27], s68 offen sc1
    s_add_u32 s68, s99, 24576
    buffer_load_dwordx4 v[92:95], v180, s[24:27], s68 offen sc1
    s_add_u32 s68, s99, 36864
    buffer_load_dwordx4 v[96:99], v180, s[24:27], s68 offen sc1
    s_add_u32 s68, s99, 45056
    buffer_load_dwordx4 v[100:103], v180, s[24:27], s68 offen sc1
    s_add_u32 s68, s99, 53248
    buffer_load_dwordx4 v[104:107], v180, s[24:27], s68 offen sc1
L_later:
    s_waitcnt vmcnt(9)
    v_mfma_f32_16x16x32_bf16 v[16:19], a[0:3], v[44:47], 0
    ds_read_b64_tr_b16 a[0:1], v176 offset:44032
    ds_read_b64_tr_b16 a[2:3], v177 offset:44032
    v_mfma_f32_16x16x32_bf16 v[20:23], a[4:7], v[44:47], 0
    ds_read_b64_tr_b16 a[4:5], v176 offset:44064
    ds_read_b64_tr_b16 a[6:7], v177 offset:44064
    v_mfma_f32_16x16x32_bf16 v[24:27], a[8:11], v[44:47], 0
    ds_read_b64_tr_b16 a[8:9], v176 offset:44096
    ds_read_b64_tr_b16 a[10:11], v177 offset:44096
    v_mfma_f32_16x16x32_bf16 v[28:31], a[12:15], v[44:47], 0
    ds_read_b64_tr_b16 a[12:13], v176 offset:50176
    ds_read_b64_tr_b16 a[14:15], v177 offset:50176
    v_mfma_f32_16x16x32_bf16 v[32:35], a[16:19], v[44:47], 0
    ds_read_b64_tr_b16 a[16:17], v176 offset:50208
    ds_read_b64_tr_b16 a[18:19], v177 offset:50208
    v_mfma_f32_16x16x32_bf16 v[36:39], a[20:23], v[44:47], 0
    ds_read_b64_tr_b16 a[20:21], v176 offset:50240
    ds_read_b64_tr_b16 a[22:23], v177 offset:50240
    v_mfma_f32_16x16x32_bf16 v[40:43], a[24:27], v[44:47], 0
    ds_read_b64_tr_b16 a[24:25], v176 offset:50272
    ds_read_b64_tr_b16 a[26:27], v177 offset:50272
    s_waitcnt vmcnt(8) lgkmcnt(12)
    v_mfma_f32_16x16x32_bf16 v[16:19], a[28:31], v[48:51], v[16:19]
    ds_read_b64_tr_b16 a[28:29], v176 offset:50304
    ds_read_b64_tr_b16 a[30:31], v177 offset:50304
    s_waitcnt lgkmcnt(12)
    v_mfma_f32_16x16x32_bf16 v[20:23], a[32:35], v[48:51], v[20:23]
    ds_read_b64_tr_b16 a[32:33], v176 offset:50336
    ds_read_b64_tr_b16 a[34:35], v177 offset:50336
    s_waitcnt lgkmcnt(12)
    v_mfma_f32_16x16x32_bf16 v[24:27], a[36:39], v[48:51], v[24:27]
    ds_read_b64_tr_b16 a[36:37], v176 offset:50368
    ds_read_b64_tr_b16 a[38:39], v177 offset:50368
    s_waitcnt lgkmcnt(12)
    v_mfma_f32_16x16x32_bf16 v[28:31], a[40:43], v[48:51], v[28:31]
    ds_read_b64_tr_b16 a[40:41], v178 offset:0
    ds_read_b64_tr_b16 a[42:43], v191 offset:0
    s_waitcnt lgkmcnt(12)
    v_mfma_f32_16x16x32_bf16 v[32:35], a[44:47], v[48:51], v[32:35]
    ds_read_b64_tr_b16 a[44:45], v178 offset:32
    ds_read_b64_tr_b16 a[46:47], v191 offset:32
    s_waitcnt lgkmcnt(12)
    v_mfma_f32_16x16x32_bf16 v[36:39], a[48:51], v[48:51], v[36:39]
    ds_read_b64_tr_b16 a[48:49], v178 offset:64
    ds_read_b64_tr_b16 a[50:51], v191 offset:64
    s_waitcnt lgkmcnt(12)
    v_mfma_f32_16x16x32_bf16 v[40:43], a[52:55], v[48:51], v[40:43]
    ds_read_b64_tr_b16 a[52:53], v178 offset:96
    ds_read_b64_tr_b16 a[54:55], v191 offset:96
    s_waitcnt vmcnt(7) lgkmcnt(12)
    v_mfma_f32_16x16x32_bf16 v[16:19], a[56:59], v[52:55], v[16:19]
    ds_read_b64_tr_b16 a[56:57], v178 offset:128
    ds_read_b64_tr_b16 a[58:59], v191 offset:128
    s_waitcnt lgkmcnt(12)
    v_mfma_f32_16x16x32_bf16 v[20:23], a[60:63], v[52:55], v[20:23]
    ds_read_b64_tr_b16 a[60:61], v178 offset:160
    ds_read_b64_tr_b16 a[62:63], v191 offset:160
    s_waitcnt lgkmcnt(12)
    v_mfma_f32_16x16x32_bf16 v[24:27], v[108:111], v[52:55], v[24:27]
    ds_read_b64_tr_b16 v[108:109], v178 offset:192
    ds_read_b64_tr_b16 v[110:111], v191 offset:192
    s_waitcnt lgkmcnt(12)
    v_mfma_f32_16x16x32_bf16 v[28:31], v[112:115], v[52:55], v[28:31]
    ds_read_b64_tr_b16 v[112:113], v178 offset:12544
    ds_read_b64_tr_b16 v[114:115], v191 offset:12544
    s_waitcnt lgkmcnt(12)
    v_mfma_f32_16x16x32_bf16 v[32:35], v[116:119], v[52:55], v[32:35]
    ds_read_b64_tr_b16 v[116:117], v178 offset:12576
    ds_read_b64_tr_b16 v[118:119], v191 offset:12576
    s_waitcnt lgkmcnt(12)
    v_mfma_f32_16x16x32_bf16 v[36:39], v[120:123], v[52:55], v[36:39]
    ds_read_b64_tr_b16 v[120:121], v178 offset:12608
    ds_read_b64_tr_b16 v[122:123], v191 offset:12608
    s_waitcnt lgkmcnt(12)
    v_mfma_f32_16x16x32_bf16 v[40:43], v[124:127], v[52:55], v[40:43]
    ds_read_b64_tr_b16 v[124:125], v178 offset:12640
    ds_read_b64_tr_b16 v[126:127], v191 offset:12640
    s_waitcnt vmcnt(6) lgkmcnt(12)
    v_mfma_f32_16x16x32_bf16 v[16:19], v[128:131], v[56:59], v[16:19]
    ds_read_b64_tr_b16 v[128:129], v178 offset:12672
    ds_read_b64_tr_b16 v[130:131], v191 offset:12672
    s_waitcnt lgkmcnt(12)
    v_mfma_f32_16x16x32_bf16 v[20:23], v[132:135], v[56:59], v[20:23]
    ds_read_b64_tr_b16 v[132:133], v178 offset:12704
    ds_read_b64_tr_b16 v[134:135], v191 offset:12704
    s_waitcnt lgkmcnt(12)
    v_mfma_f32_16x16x32_bf16 v[24:27], v[136:139], v[56:59], v[24:27]
    ds_read_b64_tr_b16 v[136:137], v178 offset:12736
    ds_read_b64_tr_b16 v[138:139], v191 offset:12736
    s_waitcnt lgkmcnt(12)
    v_mfma_f32_16x16x32_bf16 v[28:31], v[140:143], v[56:59], v[28:31]
    ds_read_b64_tr_b16 v[140:141], v178 offset:25088
    ds_read_b64_tr_b16 v[142:143], v191 offset:25088
    s_waitcnt lgkmcnt(12)
    v_mfma_f32_16x16x32_bf16 v[32:35], v[144:147], v[56:59], v[32:35]
    ds_read_b64_tr_b16 v[144:145], v178 offset:25120
    ds_read_b64_tr_b16 v[146:147], v191 offset:25120
    s_waitcnt lgkmcnt(12)
    v_mfma_f32_16x16x32_bf16 v[36:39], v[148:151], v[56:59], v[36:39]
    ds_read_b64_tr_b16 v[148:149], v178 offset:25152
    ds_read_b64_tr_b16 v[150:151], v191 offset:25152
    s_waitcnt lgkmcnt(12)
    v_mfma_f32_16x16x32_bf16 v[40:43], v[152:155], v[56:59], v[40:43]
    ds_read_b64_tr_b16 v[152:153], v178 offset:25184
    ds_read_b64_tr_b16 v[154:155], v191 offset:25184
    ds_read_b32 v12, v7 offset:4
    s_cmp_lg_u32 s57, 0
    s_cbranch_scc1 L_ck1
    s_waitcnt vmcnt(0) lgkmcnt(0)
    v_cmp_ne_u32 vcc, s36, v12
    s_nop 1
    s_cbranch_vccnz L_ck2
    s_mov_b32 s57, 1
    s_add_u32 s68, s99, 8192
    buffer_load_dwordx4 v[84:87], v180, s[24:27], s68 offen sc1
    s_add_u32 s68, s99, 16384
    buffer_load_dwordx4 v[88:91], v180, s[24:27], s68 offen sc1
    s_add_u32 s68, s99, 24576
    buffer_load_dwordx4 v[92:95], v180, s[24:27], s68 offen sc1
    s_add_u32 s68, s99, 36864
    buffer_load_dwordx4 v[96:99], v180, s[24:27], s68 offen sc1
    s_add_u32 s68, s99, 45056
    buffer_load_dwordx4 v[100:103], v180, s[24:27], s68 offen sc1
    s_add_u32 s68, s99, 53248
    buffer_load_dwordx4 v[104:107], v180, s[24:27], s68 offen sc1
L_ck1:
    s_waitcnt vmcnt(6) lgkmcnt(0)
L_ck2:
    v_mfma_f32_16x16x32_bf16 v[16:19], v[156:159], v[60:63], v[16:19]
    ds_read_b64_tr_b16 v[156:157], v178 offset:25216
    ds_read_b64_tr_b16 v[158:159], v191 offset:25216
    v_mfma_f32_16x16x32_bf16 v[20:23], v[160:163], v[60:63], v[20:23]
    ds_read_b64_tr_b16 v[160:161], v178 offset:25248
    ds_read_b64_tr_b16 v[162:163], v191 offset:25248
    v_mfma_f32_16x16x32_bf16 v[24:27], v[164:167], v[60:63], v[24:27]
    ds_read_b64_tr_b16 v[164:165], v178 offset:25280
    ds_read_b64_tr_b16 v[166:167], v191 offset:25280
    v_mfma_f32_16x16x32_bf16 v[28:31], v[168:171], v[60:63], v[28:31]
    ds_read_b64_tr_b16 v[168:169], v178 offset:31360
    ds_read_b64_tr_b16 v[170:171], v191 offset:31360
    v_mfma_f32_16x16x32_bf16 v[32:35], a[0:3], v[60:63], v[32:35]
    ds_read_b64_tr_b16 a[0:1], v178 offset:31392
    ds_read_b64_tr_b16 a[2:3], v191 offset:31392
    v_mfma_f32_16x16x32_bf16 v[36:39], a[4:7], v[60:63], v[36:39]
    ds_read_b64_tr_b16 a[4:5], v178 offset:31424
    ds_read_b64_tr_b16 a[6:7], v191 offset:31424
    v_mfma_f32_16x16x32_bf16 v[40:43], a[8:11], v[60:63], v[40:43]
    ds_read_b64_tr_b16 a[8:9], v178 offset:31456
    ds_read_b64_tr_b16 a[10:11], v191 offset:31456
    s_waitcnt lgkmcnt(12)
    v_mfma_f32_16x16x32_bf16 v[16:19], a[12:15], v[64:67], v[16:19]
    ds_read_b64_tr_b16 a[12:13], v178 offset:31488
    ds_read_b64_tr_b16 a[14:15], v191 offset:31488
    s_waitcnt lgkmcnt(12)
    v_mfma_f32_16x16x32_bf16 v[20:23], a[16:19], v[64:67], v[20:23]
    ds_read_b64_tr_b16 a[16:17], v178 offset:31520
    ds_read_b64_tr_b16 a[18:19], v191 offset:31520
    s_waitcnt lgkmcnt(12)
    v_mfma_f32_16x16x32_bf16 v[24:27], a[20:23], v[64:67], v[24:27]
    ds_read_b64_tr_b16 a[20:21], v178 offset:31552
    ds_read_b64_tr_b16 a[22:23], v191 offset:31552
    s_waitcnt lgkmcnt(12)
    v_mfma_f32_16x16x32_bf16 v[28:31], a[24:27], v[64:67], v[28:31]
    ds_read_b64_tr_b16 a[24:25], v176 offset:12544
    ds_read_b64_tr_b16 a[26:27], v177 offset:12544
    s_waitcnt lgkmcnt(12)
    v_mfma_f32_16x16x32_bf16 v[32:35], a[28:31], v[64:67], v[32:35]
    ds_read_b64_tr_b16 a[28:29], v176 offset:12576
    ds_read_b64_tr_b16 a[30:31], v177 offset:12576
    s_waitcnt lgkmcnt(12)
    v_mfma_f32_16x16x32_bf16 v[36:39], a[32:35], v[64:67], v[36:39]
    ds_read_b64_tr_b16 a[32:33], v176 offset:12608
    ds_read_b64_tr_b16 a[34:35], v177 offset:12608
    s_waitcnt lgkmcnt(12)
    v_mfma_f32_16x16x32_bf16 v[40:43], a[36:39], v[64:67], v[40:43]
    ds_read_b64_tr_b16 a[36:37], v176 offset:12640
    ds_read_b64_tr_b16 a[38:39], v177 offset:12640
    s_waitcnt lgkmcnt(12)
    v_mfma_f32_16x16x32_bf16 v[16:19], a[40:43], v[68:71], v[16:19]
    ds_read_b64_tr_b16 a[40:41], v176 offset:12672
    ds_read_b64_tr_b16 a[42:43], v177 offset:12672
    s_waitcnt lgkmcnt(12)
    v_mfma_f32_16x16x32_bf16 v[20:23], a[44:47], v[68:71], v[20:23]
    ds_read_b64_tr_b16 a[44:45], v176 offset:12704
    ds_read_b64_tr_b16 a[46:47], v177 offset:12704
    s_waitcnt lgkmcnt(12)
    v_mfma_f32_16x16x32_bf16 v[24:27], a[48:51], v[68:71], v[24:27]
    ds_read_b64_tr_b16 a[48:49], v176 offset:12736
    ds_read_b64_tr_b16 a[50:51], v177 offset:12736
    s_waitcnt lgkmcnt(12)
    v_mfma_f32_16x16x32_bf16 v[28:31], a[52:55], v[68:71], v[28:31]
    ds_read_b64_tr_b16 a[52:53], v176 offset:25088
    ds_read_b64_tr_b16 a[54:55], v177 offset:25088
    s_waitcnt lgkmcnt(12)
    v_mfma_f32_16x16x32_bf16 v[32:35], a[56:59], v[68:71], v[32:35]
    ds_read_b64_tr_b16 a[56:57], v176 offset:25120
    ds_read_b64_tr_b16 a[58:59], v177 offset:25120
    s_waitcnt lgkmcnt(12)
    v_mfma_f32_16x16x32_bf16 v[36:39], a[60:63], v[68:71], v[36:39]
    ds_read_b64_tr_b16 a[60:61], v176 offset:25152
    ds_read_b64_tr_b16 a[62:63], v177 offset:25152
    s_waitcnt lgkmcnt(12)
    v_mfma_f32_16x16x32_bf16 v[40:43], v[108:111], v[68:71], v[40:43]
    ds_read_b64_tr_b16 v[108:109], v176 offset:25184
    ds_read_b64_tr_b16 v[110:111], v177 offset:25184
    s_cmp_lg_u32 s57, 0
    s_cbranch_scc1 L_ckb7
    ds_read_b32 v12, v7 offset:4
    s_waitcnt lgkmcnt(0)
    v_cmp_ne_u32 vcc, s36, v12
    s_nop 1
    s_cbranch_vccnz L_ckb7
    s_mov_b32 s57, 1
    s_add_u32 s68, s99, 8192
    buffer_load_dwordx4 v[84:87], v180, s[24:27], s68 offen sc1
    s_add_u32 s68, s99, 16384
    buffer_load_dwordx4 v[88:91], v180, s[24:27], s68 offen sc1
    s_add_u32 s68, s99, 24576
    buffer_load_dwordx4 v[92:95], v180, s[24:27], s68 offen sc1
    s_add_u32 s68, s99, 36864
    buffer_load_dwordx4 v[96:99], v180, s[24:27], s68 offen sc1
    s_add_u32 s68, s99, 45056
    buffer_load_dwordx4 v[100:103], v180, s[24:27], s68 offen sc1
    s_add_u32 s68, s99, 53248
    buffer_load_dwordx4 v[104:107], v180, s[24:27], s68 offen sc1
L_ckb7:
    s_waitcnt lgkmcnt(12)
    v_mfma_f32_16x16x32_bf16 v[16:19], v[112:115], v[72:75], v[16:19]
    ds_read_b64_tr_b16 v[112:113], v176 offset:25216
    ds_read_b64_tr_b16 v[114:115], v177 offset:25216
    s_waitcnt lgkmcnt(12)
    v_mfma_f32_16x16x32_bf16 v[20:23], v[116:119], v[72:75], v[20:23]
    ds_read_b64_tr_b16 v[116:117], v176 offset:25248
    ds_read_b64_tr_b16 v[118:119], v177 offset:25248
    s_waitcnt lgkmcnt(12)
    v_mfma_f32_16x16x32_bf16 v[24:27], v[120:123], v[72:75], v[24:27]
    ds_read_b64_tr_b16 v[120:121], v176 offset:25280
    ds_read_b64_tr_b16 v[122:123], v177 offset:25280
    s_waitcnt lgkmcnt(12)
    v_mfma_f32_16x16x32_bf16 v[28:31], v[124:127], v[72:75], v[28:31]
    ds_read_b64_tr_b16 v[124:125], v176 offset:37632
    ds_read_b64_tr_b16 v[126:127], v177 offset:37632
    s_waitcnt lgkmcnt(12)
    v_mfma_f32_16x16x32_bf16 v[32:35], v[128:131], v[72:75], v[32:35]
    ds_read_b64_tr_b16 v[128:129], v176 offset:37664
    ds_read_b64_tr_b16 v[130:131], v177 offset:37664
    s_waitcnt lgkmcnt(12)
    v_mfma_f32_16x16x32_bf16 v[36:39], v[132:135], v[72:75], v[36:39]
    ds_read_b64_tr_b16 v[132:133], v176 offset:37696
    ds_read_b64_tr_b16 v[134:135], v177 offset:37696
    s_waitcnt lgkmcnt(12)
    v_mfma_f32_16x16x32_bf16 v[40:43], v[136:139], v[72:75], v[40:43]
    ds_read_b64_tr_b16 v[136:137], v176 offset:37728
    ds_read_b64_tr_b16 v[138:139], v177 offset:37728
    s_waitcnt lgkmcnt(12)
    v_mfma_f32_16x16x32_bf16 v[16:19], v[140:143], v[76:79], v[16:19]
    ds_read_b64_tr_b16 v[140:141], v176 offset:37760
    ds_read_b64_tr_b16 v[142:143], v177 offset:37760
    s_waitcnt lgkmcnt(12)
    v_mfma_f32_16x16x32_bf16 v[20:23], v[144:147], v[76:79], v[20:23]
    ds_read_b64_tr_b16 v[144:145], v176 offset:37792
    ds_read_b64_tr_b16 v[146:147], v177 offset:37792
    s_waitcnt lgkmcnt(12)
    v_mfma_f32_16x16x32_bf16 v[24:27], v[148:151], v[76:79], v[24:27]
    ds_read_b64_tr_b16 v[148:149], v176 offset:37824
    ds_read_b64_tr_b16 v[150:151], v177 offset:37824
    s_waitcnt lgkmcnt(12)
    v_mfma_f32_16x16x32_bf16 v[28:31], v[152:155], v[76:79], v[28:31]
    ds_read_b64_tr_b16 v[152:153], v176 offset:56448
    ds_read_b64_tr_b16 v[154:155], v177 offset:56448
    s_waitcnt lgkmcnt(12)
    v_mfma_f32_16x16x32_bf16 v[32:35], v[156:159], v[76:79], v[32:35]
    ds_read_b64_tr_b16 v[156:157], v176 offset:56480
    ds_read_b64_tr_b16 v[158:159], v177 offset:56480
    s_waitcnt lgkmcnt(12)
    v_mfma_f32_16x16x32_bf16 v[36:39], v[160:163], v[76:79], v[36:39]
    ds_read_b64_tr_b16 v[160:161], v176 offset:56512
    ds_read_b64_tr_b16 v[162:163], v177 offset:56512
    s_waitcnt lgkmcnt(12)
    v_mfma_f32_16x16x32_bf16 v[40:43], v[164:167], v[76:79], v[40:43]
    ds_read_b64_tr_b16 v[164:165], v176 offset:56544
    ds_read_b64_tr_b16 v[166:167], v177 offset:56544
    s_waitcnt lgkmcnt(12)
    v_mfma_f32_16x16x32_bf16 v[16:19], v[168:171], v[80:83], v[16:19]
    ds_read_b64_tr_b16 v[168:169], v176 offset:56576
    ds_read_b64_tr_b16 v[170:171], v177 offset:56576
    s_waitcnt lgkmcnt(12)
    v_mfma_f32_16x16x32_bf16 v[20:23], a[0:3], v[80:83], v[20:23]
    ds_read_b64_tr_b16 a[0:1], v176 offset:56608
    ds_read_b64_tr_b16 a[2:3], v177 offset:56608
    s_waitcnt lgkmcnt(12)
    v_mfma_f32_16x16x32_bf16 v[24:27], a[4:7], v[80:83], v[24:27]
    ds_read_b64_tr_b16 a[4:5], v176 offset:56640
    ds_read_b64_tr_b16 a[6:7], v177 offset:56640
    s_waitcnt lgkmcnt(12)
    v_mfma_f32_16x16x32_bf16 v[28:31], a[8:11], v[80:83], v[28:31]
    ds_read_b64_tr_b16 a[8:9], v178 offset:6272
    ds_read_b64_tr_b16 a[10:11], v191 offset:6272
    s_waitcnt lgkmcnt(12)
    v_mfma_f32_16x16x32_bf16 v[32:35], a[12:15], v[80:83], v[32:35]
    ds_read_b64_tr_b16 a[12:13], v178 offset:6304
    ds_read_b64_tr_b16 a[14:15], v191 offset:6304
    s_waitcnt lgkmcnt(12)
    v_mfma_f32_16x16x32_bf16 v[36:39], a[16:19], v[80:83], v[36:39]
    ds_read_b64_tr_b16 a[16:17], v178 offset:6336
    ds_read_b64_tr_b16 a[18:19], v191 offset:6336
    s_waitcnt lgkmcnt(12)
    v_mfma_f32_16x16x32_bf16 v[40:43], a[20:23], v[80:83], v[40:43]
    ds_read_b64_tr_b16 a[20:21], v178 offset:6368
    ds_read_b64_tr_b16 a[22:23], v191 offset:6368
    s_cmp_lg_u32 s57, 0
    s_cbranch_scc1 L_have
    s_mov_b32 s38, 0
L_spin1:
    ds_read_b32 v12, v7 offset:4
    s_add_u32 s38, s38, 1
    s_cmp_ge_u32 s38, 0x1000000
    s_waitcnt lgkmcnt(0)
    s_cbranch_scc1 L_spin1_ok
    v_cmp_ne_u32 vcc, s36, v12
    s_nop 1
    s_cbranch_vccz L_spin1_ok
    s_sleep 1
    s_branch L_spin1
L_spin1_ok:
    s_add_u32 s68, s99, 8192
    buffer_load_dwordx4 v[84:87], v180, s[24:27], s68 offen sc1
    s_add_u32 s68, s99, 16384
    buffer_load_dwordx4 v[88:91], v180, s[24:27], s68 offen sc1
    s_add_u32 s68, s99, 24576
    buffer_load_dwordx4 v[92:95], v180, s[24:27], s68 offen sc1
    s_add_u32 s68, s99, 36864
    buffer_load_dwordx4 v[96:99], v180, s[24:27], s68 offen sc1
    s_add_u32 s68, s99, 45056
    buffer_load_dwordx4 v[100:103], v180, s[24:27], s68 offen sc1
    s_add_u32 s68, s99, 53248
    buffer_load_dwordx4 v[104:107], v180, s[24:27], s68 offen sc1
L_have:
    s_waitcnt vmcnt(5) lgkmcnt(12)
    v_mfma_f32_16x16x32_bf16 v[16:19], a[24:27], v[84:87], v[16:19]
    ds_read_b64_tr_b16 a[24:25], v178 offset:6400
    ds_read_b64_tr_b16 a[26:27], v191 offset:6400
    s_waitcnt lgkmcnt(12)
    v_mfma_f32_16x16x32_bf16 v[20:23], a[28:31], v[84:87], v[20:23]
    ds_read_b64_tr_b16 a[28:29], v178 offset:6432
    ds_read_b64_tr_b16 a[30:31], v191 offset:6432
    s_waitcnt lgkmcnt(12)
    v_mfma_f32_16x16x32_bf16 v[24:27], a[32:35], v[84:87], v[24:27]
    ds_read_b64_tr_b16 a[32:33], v178 offset:6464
    ds_read_b64_tr_b16 a[34:35], v191 offset:6464
    s_waitcnt lgkmcnt(12)
    v_mfma_f32_16x16x32_bf16 v[28:31], a[36:39], v[84:87], v[28:31]
    ds_read_b64_tr_b16 a[36:37], v178 offset:18816
    ds_read_b64_tr_b16 a[38:39], v191 offset:18816
    s_waitcnt lgkmcnt(12)
    v_mfma_f32_16x16x32_bf16 v[32:35], a[40:43], v[84:87], v[32:35]
    ds_read_b64_tr_b16 a[40:41], v178 offset:18848
    ds_read_b64_tr_b16 a[42:43], v191 offset:18848
    s_waitcnt lgkmcnt(12)
    v_mfma_f32_16x16x32_bf16 v[36:39], a[44:47], v[84:87], v[36:39]
    ds_read_b64_tr_b16 a[44:45], v178 offset:18880
    ds_read_b64_tr_b16 a[46:47], v191 offset:18880
    s_waitcnt lgkmcnt(12)
    v_mfma_f32_16x16x32_bf16 v[40:43], a[48:51], v[84:87], v[40:43]
    ds_read_b64_tr_b16 a[48:49], v178 offset:18912
    ds_read_b64_tr_b16 a[50:51], v191 offset:18912
    s_waitcnt vmcnt(4) lgkmcnt(12)
    v_mfma_f32_16x16x32_bf16 v[16:19], a[52:55], v[88:91], v[16:19]
    ds_read_b64_tr_b16 a[52:53], v178 offset:18944
    ds_read_b64_tr_b16 a[54:55], v191 offset:18944
    s_waitcnt lgkmcnt(12)
    v_mfma_f32_16x16x32_bf16 v[20:23], a[56:59], v[88:91], v[20:23]
    ds_read_b64_tr_b16 a[56:57], v178 offset:18976
    ds_read_b64_tr_b16 a[58:59], v191 offset:18976
    s_waitcnt lgkmcnt(12)
    v_mfma_f32_16x16x32_bf16 v[24:27], a[60:63], v[88:91], v[24:27]
    ds_read_b64_tr_b16 a[60:61], v178 offset:19008
    ds_read_b64_tr_b16 a[62:63], v191 offset:19008
    s_waitcnt lgkmcnt(12)
    v_mfma_f32_16x16x32_bf16 v[28:31], v[108:111], v[88:91], v[28:31]
    v_mfma_f32_16x16x32_bf16 v[32:35], v[112:115], v[88:91], v[32:35]
    v_mfma_f32_16x16x32_bf16 v[36:39], v[116:119], v[88:91], v[36:39]
    v_mfma_f32_16x16x32_bf16 v[40:43], v[120:123], v[88:91], v[40:43]
    s_waitcnt vmcnt(3)
    v_mfma_f32_16x16x32_bf16 v[16:19], v[124:127], v[92:95], v[16:19]
    v_mfma_f32_16x16x32_bf16 v[20:23], v[128:131], v[92:95], v[20:23]
    v_mfma_f32_16x16x32_bf16 v[24:27], v[132:135], v[92:95], v[24:27]
    v_mfma_f32_16x16x32_bf16 v[28:31], v[136:139], v[92:95], v[28:31]
    v_mfma_f32_16x16x32_bf16 v[32:35], v[140:143], v[92:95], v[32:35]
    v_mfma_f32_16x16x32_bf16 v[36:39], v[144:147], v[92:95], v[36:39]
    v_mfma_f32_16x16x32_bf16 v[40:43], v[148:151], v[92:95], v[40:43]
    s_waitcnt vmcnt(2)
    v_mfma_f32_16x16x32_bf16 v[16:19], v[152:155], v[96:99], v[16:19]
    v_mfma_f32_16x16x32_bf16 v[20:23], v[156:159], v[96:99], v[20:23]
    v_mfma_f32_16x16x32_bf16 v[24:27], v[160:163], v[96:99], v[24:27]
    v_mfma_f32_16x16x32_bf16 v[28:31], v[164:167], v[96:99], v[28:31]
    v_mfma_f32_16x16x32_bf16 v[32:35], v[168:171], v[96:99], v[32:35]
    v_mfma_f32_16x16x32_bf16 v[36:39], a[0:3], v[96:99], v[36:39]
    v_mfma_f32_16x16x32_bf16 v[40:43], a[4:7], v[96:99], v[40:43]
    s_waitcnt vmcnt(1)
    v_mfma_f32_16x16x32_bf16 v[16:19], a[8:11], v[100:103], v[16:19]
    v_mfma_f32_16x16x32_bf16 v[20:23], a[12:15], v[100:103], v[20:23]
    v_mfma_f32_16x16x32_bf16 v[24:27], a[16:19], v[100:103], v[24:27]
    v_mfma_f32_16x16x32_bf16 v[28:31], a[20:23], v[100:103], v[28:31]
    v_mfma_f32_16x16x32_bf16 v[32:35], a[24:27], v[100:103], v[32:35]
    v_mfma_f32_16x16x32_bf16 v[36:39], a[28:31], v[100:103], v[36:39]
    v_mfma_f32_16x16x32_bf16 v[40:43], a[32:35], v[100:103], v[40:43]
    s_waitcnt vmcnt(0)
    v_mfma_f32_16x16x32_bf16 v[16:19], a[36:39], v[104:107], v[16:19]
    s_waitcnt lgkmcnt(10)
    v_mfma_f32_16x16x32_bf16 v[20:23], a[40:43], v[104:107], v[20:23]
    s_waitcnt lgkmcnt(8)
    v_mfma_f32_16x16x32_bf16 v[24:27], a[44:47], v[104:107], v[24:27]
    s_waitcnt lgkmcnt(6)
    v_mfma_f32_16x16x32_bf16 v[28:31], a[48:51], v[104:107], v[28:31]
    s_waitcnt lgkmcnt(4)
    v_mfma_f32_16x16x32_bf16 v[32:35], a[52:55], v[104:107], v[32:35]
    s_waitcnt lgkmcnt(2)
    v_mfma_f32_16x16x32_bf16 v[36:39], a[56:59], v[104:107], v[36:39]
    s_waitcnt lgkmcnt(0)
    v_mfma_f32_16x16x32_bf16 v[40:43], a[60:63], v[104:107], v[40:43]
    s_nop 1
    v_cvt_pk_bf16_f32 v108, v16, v17
    v_cvt_pk_bf16_f32 v109, v18, v19
    v_cvt_pk_bf16_f32 v110, v20, v21
    v_cvt_pk_bf16_f32 v111, v22, v23
    v_cvt_pk_bf16_f32 v112, v24, v25
    v_cvt_pk_bf16_f32 v113, v26, v27
    v_permlane16_swap_b32 v108, v110
    v_permlane16_swap_b32 v109, v111
    ds_write_b128 v188, v[108:111] offset:0
    v_cvt_pk_bf16_f32 v114, v28, v29
    v_cvt_pk_bf16_f32 v115, v30, v31
    v_cvt_pk_bf16_f32 v116, v32, v33
    v_cvt_pk_bf16_f32 v117, v34, v35
    v_permlane16_swap_b32 v112, v114
    v_permlane16_swap_b32 v113, v115
    ds_write_b128 v188, v[112:115] offset:64
    v_cvt_pk_bf16_f32 v118, v36, v37
    v_cvt_pk_bf16_f32 v119, v38, v39
    v_cvt_pk_bf16_f32 v120, v40, v41
    v_cvt_pk_bf16_f32 v121, v42, v43
    v_permlane16_swap_b32 v116, v118
    v_permlane16_swap_b32 v117, v119
    ds_write_b128 v188, v[116:119] offset:128
    ds_write_b64 v189, v[120:121] offset:192
    s_waitcnt lgkmcnt(0)
    ds_read_b128 v[44:47], v184
    ds_read_b128 v[48:51], v185
    ds_read_b128 v[52:55], v186
    ds_read_b128 v[56:59], v187
    s_waitcnt lgkmcnt(3)
    buffer_store_dwordx4 v[44:47], v172, s[16:19], s98 offen nt
    s_waitcnt lgkmcnt(2)
    buffer_store_dwordx4 v[48:51], v173, s[16:19], s98 offen nt
    s_waitcnt lgkmcnt(1)
    buffer_store_dwordx4 v[52:55], v174, s[16:19], s98 offen nt
    s_waitcnt lgkmcnt(0)
    buffer_store_dwordx4 v[56:59], v175, s[16:19], s98 offen nt
    s_or_b32 s67, s33, s34
    s_or_b32 s67, s67, s35
    s_cmp_lg_u32 s67, 0
    s_cbranch_scc1 L_hdone
    s_lshl_b32 s67, s32, 8
    v_mov_b32 v11, s67
    buffer_store_dword v9, v11, s[28:31], 0 offen offset:0
L_hdone:
L_end:
    s_endpgm
.p2align 12
L_compute:
    s_waitcnt lgkmcnt(0)
    s_lshl_b32 s67, s37, 18
    s_add_u32 s67, s67, 0
    s_add_u32 s20, s100, s67
    s_addc_u32 s21, s101, 0
    s_mov_b32 s22, 262144
    s_mov_b32 s23, 0x20000
    s_add_u32 s24, s100, 8388608
    s_addc_u32 s25, s101, 0
    s_mov_b32 s26, 4194304
    s_mov_b32 s27, 0x20000
    s_add_u32 s28, s100, 12582912
    s_addc_u32 s29, s101, 0
    s_mov_b32 s30, 524288
    s_mov_b32 s31, 0x20000
    s_lshl_b32 s67, s32, 8
    s_add_u32 s94, s28, s67
    s_addc_u32 s95, s29, 0
    s_load_dword s36, s[94:95], 0
    s_lshl_b32 s55, s35, 12
    s_add_u32 s55, s55, 65536
    v_lshlrev_b32 v2, 4, v1
    v_and_b32 v20, 31, v1
    v_lshrrev_b32 v21, 5, v1
    v_bfe_u32 v22, v1, 1, 3
    v_xor_b32 v22, v22, v21
    v_lshlrev_b32 v22, 4, v22
    v_lshl_add_u32 v22, v20, 7, v22
    v_add_u32 v3, s55, v22
    v_xor_b32 v4, 32, v3
    v_xor_b32 v5, 64, v3
    v_xor_b32 v6, 96, v3
    v_bfe_u32 v22, v1, 2, 2
    v_lshl_add_u32 v22, v21, 3, v22
    v_lshlrev_b32 v7, 6, v22
    v_bfe_u32 v22, v1, 4, 1
    v_lshl_add_u32 v7, v22, 5, v7
    v_and_b32 v22, 3, v1
    v_lshl_add_u32 v7, v22, 3, v7
    s_cmp_eq_u32 s33, 15
    s_cselect_b32 s69, 8, 0
    v_add_u32 v7, s69, v7
    v_add_u32 v8, 131072, v7
    v_and_b32 v20, 0x33, v1
    v_bfe_u32 v21, v1, 2, 1
    v_bfe_u32 v22, v1, 3, 1
    v_lshl_or_b32 v20, v21, 3, v20
    v_lshl_or_b32 v20, v22, 2, v20
    v_lshlrev_b32 v11, 4, v20
    v_add_u32 v9, s55, v11
    v_add_u32 v10, s55, v2
    v_mov_b32 v15, 0xdddddddd
    v_and_b32 v20, 31, v1
    v_cmp_eq_u32 vcc, 28, v20
    v_mov_b32 v24, 0x3f803f80
    v_mov_b32 v25, 0x3f80
    s_mov_b32 s58, 0
    s_mov_b32 s59, -1
    v_cndmask_b32 v16, 0, v24, vcc
    s_mov_b32 s60, 0xf0000000
    s_mov_b32 s61, 0xf0000000
    s_mov_b32 s39, 0
    v_add_u32 v14, 65536, v2
    s_lshl_b32 s67, s35, 12
    v_add_u32 v26, s67, v14
    v_xor_b32 v27, 4096, v26
    v_xor_b32 v28, 8192, v26
    v_xor_b32 v29, 12288, v26
    s_mov_b32 s64, 0
    s_mov_b32 s63, 6
    s_lshl_b32 s65, s34, 15
    s_lshl_b32 s67, s35, 13
    s_add_u32 s65, s65, s67
    s_lshl_b32 s67, s37, 2
    s_add_u32 s67, s67, s35
    s_lshl_b32 s67, s67, 5
    s_add_u32 s67, s67, s34
    s_lshl_b32 s67, s67, 2
    s_add_u32 s67, s67, 4096
    v_mov_b32 v13, s67
    s_mov_b32 s66, 0x3e8b97f6
    s_cmp_eq_u32 s32, 0
    s_cselect_b64 s[4:5], s[84:85], s[90:91]
    s_mov_b32 s6, 1835008
    s_mov_b32 s7, 0x20000
    s_lshr_b32 s67, s2, 3
    s_lshl_b32 s67, s67, 2
    s_add_u32 s67, s67, s35
    s_lshr_b32 s68, s67, 4
    s_lshl_b32 s68, s68, 6
    s_and_b32 s67, s67, 15
    s_lshl_b32 s67, s67, 1
    s_add_u32 s67, s67, s68
    s_lshr_b32 s68, s34, 1
    s_lshl_b32 s68, s68, 9
    s_add_u32 s67, s67, s68
    s_mul_i32 s40, s67, 896
    v_mul_u32_u24 v57, 37, v1
    v_lshrrev_b32 v57, 8, v57
    v_mul_u32_u24 v30, 7, v57
    v_sub_u32 v30, v1, v30
    v_and_b32 v56, 1, v57
    v_lshrrev_b32 v18, 1, v57
    v_lshl_add_u32 v56, v18, 5, v56
    v_mul_u32_u24 v56, 896, v56
    v_lshl_add_u32 v56, v30, 7, v56
    s_and_b32 s68, s2, 3
    s_mul_i32 s68, s68, 2
    v_subrev_u32 v30, s68, v30
    v_add_u32 v57, 7, v30
    v_min_u32 v30, v57, v30
    v_lshl_add_u32 v30, v18, 3, v30
    v_cmp_le_u32 vcc, 4, v30
    v_cmp_gt_u32 s[42:43], 28, v1
    v_mov_b32 v57, 0x7000000
    s_and_b64 vcc, vcc, s[42:43]
    s_nop 1
    v_cndmask_b32 v56, v57, v56, vcc
    s_mov_b32 s56, 0x2b800000
    v_mov_b32 v30, 0x53800000
    s_lshl_b32 s68, s32, 3
    s_add_u32 s68, s68, s34
    s_lshl_b32 s68, s68, 2
    s_add_u32 s69, s68, s35
    s_lshl_b32 s54, s69, 16
    s_lshl_b32 s62, s33, 12
    s_add_u32 s54, s54, s62
    s_lshl_b32 s69, s69, 12
    s_lshl_b32 s62, s33, 7
    s_add_u32 s69, s69, s62
    s_add_u32 s69, s69, 65536
    v_mov_b32 v31, s69
    s_lshr_b32 s69, s33, 2
    s_add_u32 s68, s68, s69
    s_lshl_b32 s68, s68, 12
    s_add_u32 s68, s68, 65536
    v_and_b32 v19, 15, v1
    v_lshl_add_u32 v19, v19, 7, s68
    v_mov_b32 v160, 0
    v_mov_b32 v161, 0
    v_mov_b32 v162, 0
    v_mov_b32 v163, 0
    v_mov_b32 v164, 0
    v_mov_b32 v165, 0
    v_mov_b32 v166, 0
    v_mov_b32 v167, 0
    v_mov_b32 v168, 0
    v_mov_b32 v169, 0
    v_mov_b32 v170, 0
    v_mov_b32 v171, 0
    v_mov_b32 v172, 0
    v_mov_b32 v173, 0
    v_mov_b32 v174, 0
    v_mov_b32 v175, 0
    v_mov_b32 v176, 0
    v_mov_b32 v177, 0
    v_mov_b32 v178, 0
    v_mov_b32 v179, 0
    v_mov_b32 v180, 0
    v_mov_b32 v181, 0
    v_mov_b32 v182, 0
    v_mov_b32 v183, 0
    v_mov_b32 v184, 0
    v_mov_b32 v185, 0
    v_mov_b32 v186, 0
    v_mov_b32 v187, 0
    v_mov_b32 v188, 0
    v_mov_b32 v189, 0
    v_mov_b32 v190, 0
    v_mov_b32 v191, 0
L_ctouch:
    s_mov_b64 exec, 0
    s_branch L_pad0
L_padret0:
    s_branch L_pad1
L_padret1:
    s_branch L_pad2
L_padret2:
    s_mov_b64 exec, -1
    s_waitcnt lgkmcnt(0)
    s_mul_i32 s36, s36, 1664525
    s_add_u32 s36, s36, 1013904223
    v_mov_b32 v17, s36
    s_barrier
    buffer_load_dwordx2 v[50:51], v56, s[4:7], s40 offen offset:60
    ds_read_b128 a[0:3], v3 offset:0
    ds_read_b64_tr_b16 a[16:17], v7 offset:28672
    ds_read_b64_tr_b16 a[18:19], v7 offset:28928
    ds_read_b64_tr_b16 a[20:21], v8 offset:0
    ds_read_b64_tr_b16 a[22:23], v8 offset:256
    ds_read_b64_tr_b16 a[12:13], v7 offset:0
    ds_read_b64_tr_b16 a[14:15], v7 offset:256
    ds_read_b128 a[4:7], v4 offset:0
    ds_read_b64_tr_b16 a[28:29], v7 offset:29696
    ds_read_b64_tr_b16 a[30:31], v7 offset:29952
    ds_read_b64_tr_b16 a[32:33], v8 offset:1024
    ds_read_b64_tr_b16 a[34:35], v8 offset:1280
    ds_read_b64_tr_b16 a[24:25], v7 offset:1024
    ds_read_b64_tr_b16 a[26:27], v7 offset:1280
    s_waitcnt lgkmcnt(11)
    v_mfma_f32_32x32x16_bf16 v[96:111], a[16:19], a[0:3], 0
    ds_read_b128 a[8:11], v5 offset:0
    ds_read_b64_tr_b16 a[40:41], v7 offset:30720
    ds_read_b64_tr_b16 a[42:43], v7 offset:30976
    s_waitcnt lgkmcnt(12)
    v_mfma_f32_32x32x16_bf16 v[128:143], a[0:3], a[20:23], 0
    ds_read_b64_tr_b16 a[44:45], v8 offset:2048
    ds_read_b64_tr_b16 a[46:47], v8 offset:2304
    s_waitcnt lgkmcnt(12)
    v_mfma_f32_32x32x16_bf16 v[64:79], a[12:15], a[0:3], 0
    ds_read_b64_tr_b16 a[36:37], v7 offset:2048
    ds_read_b64_tr_b16 a[38:39], v7 offset:2304
    s_waitcnt lgkmcnt(11)
    v_mfma_f32_32x32x16_bf16 v[96:111], a[28:31], a[4:7], v[96:111]
    ds_read_b128 a[0:3], v6 offset:0
    ds_read_b64_tr_b16 a[16:17], v7 offset:31744
    ds_read_b64_tr_b16 a[18:19], v7 offset:32000
    s_waitcnt lgkmcnt(12)
    v_mfma_f32_32x32x16_bf16 v[128:143], a[4:7], a[32:35], v[128:143]
    ds_read_b64_tr_b16 a[20:21], v8 offset:3072
    ds_read_b64_tr_b16 a[22:23], v8 offset:3328
    s_waitcnt lgkmcnt(12)
    v_mfma_f32_32x32x16_bf16 v[64:79], a[24:27], a[4:7], v[64:79]
    ds_read_b64_tr_b16 a[12:13], v7 offset:3072
    ds_read_b64_tr_b16 a[14:15], v7 offset:3328
    s_waitcnt lgkmcnt(11)
    v_mfma_f32_32x32x16_bf16 v[96:111], a[40:43], a[8:11], v[96:111]
    s_waitcnt lgkmcnt(6)
    s_barrier
    ds_read_b128 a[4:7], v3 offset:16384
    ds_read_b64_tr_b16 a[28:29], v7 offset:32768
    ds_read_b64_tr_b16 a[30:31], v7 offset:33024
    v_mfma_f32_32x32x16_bf16 v[128:143], a[8:11], a[44:47], v[128:143]
    ds_read_b64_tr_b16 a[32:33], v8 offset:4096
    ds_read_b64_tr_b16 a[34:35], v8 offset:4352
    v_mfma_f32_32x32x16_bf16 v[64:79], a[36:39], a[8:11], v[64:79]
    ds_read_b64_tr_b16 a[24:25], v7 offset:4096
    ds_read_b64_tr_b16 a[26:27], v7 offset:4352
    s_waitcnt lgkmcnt(11)
    v_mfma_f32_32x32x16_bf16 v[96:111], a[16:19], a[0:3], v[96:111]
    ds_read_b128 a[8:11], v4 offset:16384
    ds_read_b64_tr_b16 a[40:41], v7 offset:33792
    ds_read_b64_tr_b16 a[42:43], v7 offset:34048
    s_waitcnt lgkmcnt(12)
    v_mfma_f32_32x32x16_bf16 v[128:143], a[0:3], a[20:23], v[128:143]
    ds_read_b64_tr_b16 a[44:45], v8 offset:5120
    ds_read_b64_tr_b16 a[46:47], v8 offset:5376
    s_waitcnt lgkmcnt(12)
    v_mfma_f32_32x32x16_bf16 v[64:79], a[12:15], a[0:3], v[64:79]
    ds_read_b64_tr_b16 a[36:37], v7 offset:5120
    ds_read_b64_tr_b16 a[38:39], v7 offset:5376
    s_waitcnt lgkmcnt(11)
    v_mfma_f32_32x32x16_bf16 v[96:111], a[28:31], a[4:7], v[96:111]
    ds_read_b128 a[0:3], v5 offset:16384
    ds_read_b64_tr_b16 a[16:17], v7 offset:34816
    ds_read_b64_tr_b16 a[18:19], v7 offset:35072
    s_waitcnt lgkmcnt(12)
    v_mfma_f32_32x32x16_bf16 v[128:143], a[4:7], a[32:35], v[128:143]
    ds_read_b64_tr_b16 a[20:21], v8 offset:6144
    ds_read_b64_tr_b16 a[22:23], v8 offset:6400
    s_waitcnt lgkmcnt(12)
    v_mfma_f32_32x32x16_bf16 v[64:79], a[24:27], a[4:7], v[64:79]
    ds_read_b64_tr_b16 a[12:13], v7 offset:6144
    ds_read_b64_tr_b16 a[14:15], v7 offset:6400
    s_waitcnt lgkmcnt(11)
    v_mfma_f32_32x32x16_bf16 v[96:111], a[40:43], a[8:11], v[96:111]
    ds_read_b128 a[4:7], v6 offset:16384
    ds_read_b64_tr_b16 a[28:29], v7 offset:35840
    ds_read_b64_tr_b16 a[30:31], v7 offset:36096
    s_waitcnt lgkmcnt(12)
    v_mfma_f32_32x32x16_bf16 v[128:143], a[8:11], a[44:47], v[128:143]
    ds_read_b64_tr_b16 a[32:33], v8 offset:7168
    ds_read_b64_tr_b16 a[34:35], v8 offset:7424
    s_waitcnt lgkmcnt(12)
    v_mfma_f32_32x32x16_bf16 v[64:79], a[36:39], a[8:11], v[64:79]
    ds_read_b64_tr_b16 a[24:25], v7 offset:7168
    ds_read_b64_tr_b16 a[26:27], v7 offset:7424
    s_waitcnt lgkmcnt(11)
    v_mfma_f32_32x32x16_bf16 v[96:111], a[16:19], a[0:3], v[96:111]
    s_waitcnt lgkmcnt(6)
    s_barrier
    ds_read_b128 a[8:11], v3 offset:32768
    ds_read_b64_tr_b16 a[40:41], v7 offset:36864
    ds_read_b64_tr_b16 a[42:43], v7 offset:37120
    v_mfma_f32_32x32x16_bf16 v[128:143], a[0:3], a[20:23], v[128:143]
    ds_read_b64_tr_b16 a[44:45], v8 offset:8192
    ds_read_b64_tr_b16 a[46:47], v8 offset:8448
    v_mfma_f32_32x32x16_bf16 v[64:79], a[12:15], a[0:3], v[64:79]
    ds_read_b64_tr_b16 a[36:37], v7 offset:8192
    ds_read_b64_tr_b16 a[38:39], v7 offset:8448
    s_waitcnt lgkmcnt(11)
    v_mfma_f32_32x32x16_bf16 v[96:111], a[28:31], a[4:7], v[96:111]
    ds_read_b128 a[0:3], v4 offset:32768
    ds_read_b64_tr_b16 a[16:17], v7 offset:37888
    ds_read_b64_tr_b16 a[18:19], v7 offset:38144
    s_waitcnt lgkmcnt(12)
    v_mfma_f32_32x32x16_bf16 v[128:143], a[4:7], a[32:35], v[128:143]
    ds_read_b64_tr_b16 a[20:21], v8 offset:9216
    ds_read_b64_tr_b16 a[22:23], v8 offset:9472
    s_waitcnt lgkmcnt(12)
    v_mfma_f32_32x32x16_bf16 v[64:79], a[24:27], a[4:7], v[64:79]
    ds_read_b64_tr_b16 a[12:13], v7 offset:9216
    ds_read_b64_tr_b16 a[14:15], v7 offset:9472
    s_waitcnt lgkmcnt(11)
    v_mfma_f32_32x32x16_bf16 v[96:111], a[40:43], a[8:11], v[96:111]
    ds_read_b128 a[4:7], v5 offset:32768
    ds_read_b64_tr_b16 a[28:29], v7 offset:38912
    ds_read_b64_tr_b16 a[30:31], v7 offset:39168
    s_waitcnt lgkmcnt(12)
    v_mfma_f32_32x32x16_bf16 v[128:143], a[8:11], a[44:47], v[128:143]
    ds_read_b64_tr_b16 a[32:33], v8 offset:10240
    ds_read_b64_tr_b16 a[34:35], v8 offset:10496
    s_waitcnt lgkmcnt(12)
    v_mfma_f32_32x32x16_bf16 v[64:79], a[36:39], a[8:11], v[64:79]
    ds_read_b64_tr_b16 a[24:25], v7 offset:10240
    ds_read_b64_tr_b16 a[26:27], v7 offset:10496
    s_waitcnt lgkmcnt(11)
    v_mfma_f32_32x32x16_bf16 v[96:111], a[16:19], a[0:3], v[96:111]
    ds_read_b128 a[8:11], v6 offset:32768
    ds_read_b64_tr_b16 a[40:41], v7 offset:39936
    ds_read_b64_tr_b16 a[42:43], v7 offset:40192
    s_waitcnt lgkmcnt(12)
    v_mfma_f32_32x32x16_bf16 v[128:143], a[0:3], a[20:23], v[128:143]
    ds_read_b64_tr_b16 a[44:45], v8 offset:11264
    ds_read_b64_tr_b16 a[46:47], v8 offset:11520
    s_waitcnt lgkmcnt(12)
    v_mfma_f32_32x32x16_bf16 v[64:79], a[12:15], a[0:3], v[64:79]
    ds_read_b64_tr_b16 a[36:37], v7 offset:11264
    ds_read_b64_tr_b16 a[38:39], v7 offset:11520
    s_waitcnt lgkmcnt(11)
    v_mfma_f32_32x32x16_bf16 v[96:111], a[28:31], a[4:7], v[96:111]
    s_waitcnt lgkmcnt(6)
    s_barrier
    ds_read_b128 a[0:3], v3 offset:49152
    ds_read_b64_tr_b16 a[16:17], v7 offset:40960
    ds_read_b64_tr_b16 a[18:19], v7 offset:41216
    v_mfma_f32_32x32x16_bf16 v[128:143], a[4:7], a[32:35], v[128:143]
    ds_read_b64_tr_b16 a[20:21], v8 offset:12288
    ds_read_b64_tr_b16 a[22:23], v8 offset:12544
    v_mfma_f32_32x32x16_bf16 v[64:79], a[24:27], a[4:7], v[64:79]
    ds_read_b64_tr_b16 a[12:13], v7 offset:12288
    ds_read_b64_tr_b16 a[14:15], v7 offset:12544
    s_waitcnt lgkmcnt(11)
    v_mfma_f32_32x32x16_bf16 v[96:111], a[40:43], a[8:11], v[96:111]
    ds_read_b128 a[4:7], v4 offset:49152
    ds_read_b64_tr_b16 a[28:29], v7 offset:41984
    ds_read_b64_tr_b16 a[30:31], v7 offset:42240
    s_waitcnt lgkmcnt(12)
    v_mfma_f32_32x32x16_bf16 v[128:143], a[8:11], a[44:47], v[128:143]
    ds_read_b64_tr_b16 a[32:33], v8 offset:13312
    ds_read_b64_tr_b16 a[34:35], v8 offset:13568
    s_waitcnt lgkmcnt(12)
    v_mfma_f32_32x32x16_bf16 v[64:79], a[36:39], a[8:11], v[64:79]
    ds_read_b64_tr_b16 a[24:25], v7 offset:13312
    ds_read_b64_tr_b16 a[26:27], v7 offset:13568
    s_waitcnt lgkmcnt(11)
    v_mfma_f32_32x32x16_bf16 v[96:111], a[16:19], a[0:3], v[96:111]
    ds_read_b128 a[8:11], v5 offset:49152
    ds_read_b64_tr_b16 a[40:41], v7 offset:43008
    ds_read_b64_tr_b16 a[42:43], v7 offset:43264
    s_waitcnt lgkmcnt(12)
    v_mfma_f32_32x32x16_bf16 v[128:143], a[0:3], a[20:23], v[128:143]
    ds_read_b64_tr_b16 a[44:45], v8 offset:14336
    ds_read_b64_tr_b16 a[46:47], v8 offset:14592
    s_waitcnt lgkmcnt(12)
    v_mfma_f32_32x32x16_bf16 v[64:79], a[12:15], a[0:3], v[64:79]
    ds_read_b64_tr_b16 a[36:37], v7 offset:14336
    ds_read_b64_tr_b16 a[38:39], v7 offset:14592
    s_waitcnt lgkmcnt(11)
    v_mfma_f32_32x32x16_bf16 v[96:111], a[28:31], a[4:7], v[96:111]
    ds_read_b128 a[0:3], v6 offset:49152
    ds_read_b64_tr_b16 a[16:17], v7 offset:44032
    ds_read_b64_tr_b16 a[18:19], v7 offset:44288
    s_waitcnt lgkmcnt(12)
    v_mfma_f32_32x32x16_bf16 v[128:143], a[4:7], a[32:35], v[128:143]
    ds_read_b64_tr_b16 a[20:21], v8 offset:15360
    ds_read_b64_tr_b16 a[22:23], v8 offset:15616
    s_waitcnt lgkmcnt(12)
    v_mfma_f32_32x32x16_bf16 v[64:79], a[24:27], a[4:7], v[64:79]
    ds_read_b64_tr_b16 a[12:13], v7 offset:15360
    ds_read_b64_tr_b16 a[14:15], v7 offset:15616
    s_waitcnt lgkmcnt(11)
    v_mfma_f32_32x32x16_bf16 v[96:111], a[40:43], a[8:11], v[96:111]
    s_waitcnt lgkmcnt(6)
    s_barrier
    ds_read_b128 a[4:7], v3 offset:0
    ds_read_b64_tr_b16 a[28:29], v7 offset:45056
    ds_read_b64_tr_b16 a[30:31], v7 offset:45312
    v_mfma_f32_32x32x16_bf16 v[128:143], a[8:11], a[44:47], v[128:143]
    ds_read_b64_tr_b16 a[32:33], v8 offset:16384
    ds_read_b64_tr_b16 a[34:35], v8 offset:16640
    v_mfma_f32_32x32x16_bf16 v[64:79], a[36:39], a[8:11], v[64:79]
    ds_read_b64_tr_b16 a[24:25], v7 offset:16384
    ds_read_b64_tr_b16 a[26:27], v7 offset:16640
    s_waitcnt lgkmcnt(11)
    v_mfma_f32_32x32x16_bf16 v[96:111], a[16:19], a[0:3], v[96:111]
    ds_read_b128 a[8:11], v4 offset:0
    ds_read_b64_tr_b16 a[40:41], v7 offset:46080
    ds_read_b64_tr_b16 a[42:43], v7 offset:46336
    s_waitcnt lgkmcnt(12)
    v_mfma_f32_32x32x16_bf16 v[128:143], a[0:3], a[20:23], v[128:143]
    ds_read_b64_tr_b16 a[44:45], v8 offset:17408
    ds_read_b64_tr_b16 a[46:47], v8 offset:17664
    s_waitcnt lgkmcnt(12)
    v_mfma_f32_32x32x16_bf16 v[64:79], a[12:15], a[0:3], v[64:79]
    ds_read_b64_tr_b16 a[36:37], v7 offset:17408
    ds_read_b64_tr_b16 a[38:39], v7 offset:17664
    s_waitcnt lgkmcnt(11)
    v_mfma_f32_32x32x16_bf16 v[96:111], a[28:31], a[4:7], v[96:111]
    ds_read_b128 a[0:3], v5 offset:0
    ds_read_b64_tr_b16 a[16:17], v7 offset:47104
    ds_read_b64_tr_b16 a[18:19], v7 offset:47360
    s_waitcnt lgkmcnt(12)
    v_mfma_f32_32x32x16_bf16 v[128:143], a[4:7], a[32:35], v[128:143]
    ds_read_b64_tr_b16 a[20:21], v8 offset:18432
    ds_read_b64_tr_b16 a[22:23], v8 offset:18688
    s_waitcnt lgkmcnt(12)
    v_mfma_f32_32x32x16_bf16 v[64:79], a[24:27], a[4:7], v[64:79]
    ds_read_b64_tr_b16 a[12:13], v7 offset:18432
    ds_read_b64_tr_b16 a[14:15], v7 offset:18688
    s_waitcnt lgkmcnt(11)
    v_mfma_f32_32x32x16_bf16 v[96:111], a[40:43], a[8:11], v[96:111]
    ds_read_b128 a[4:7], v6 offset:0
    ds_read_b64_tr_b16 a[28:29], v7 offset:48128
    ds_read_b64_tr_b16 a[30:31], v7 offset:48384
    s_waitcnt lgkmcnt(12)
    v_mfma_f32_32x32x16_bf16 v[128:143], a[8:11], a[44:47], v[128:143]
    ds_read_b64_tr_b16 a[32:33], v8 offset:19456
    ds_read_b64_tr_b16 a[34:35], v8 offset:19712
    s_waitcnt lgkmcnt(12)
    v_mfma_f32_32x32x16_bf16 v[64:79], a[36:39], a[8:11], v[64:79]
    ds_read_b64_tr_b16 a[24:25], v7 offset:19456
    ds_read_b64_tr_b16 a[26:27], v7 offset:19712
    s_waitcnt lgkmcnt(11)
    v_mfma_f32_32x32x16_bf16 v[96:111], a[16:19], a[0:3], v[96:111]
    s_waitcnt lgkmcnt(6)
    s_barrier
    ds_read_b128 a[8:11], v3 offset:16384
    ds_read_b64_tr_b16 a[40:41], v7 offset:49152
    ds_read_b64_tr_b16 a[42:43], v7 offset:49408
    v_mfma_f32_32x32x16_bf16 v[128:143], a[0:3], a[20:23], v[128:143]
    ds_read_b64_tr_b16 a[44:45], v8 offset:20480
    ds_read_b64_tr_b16 a[46:47], v8 offset:20736
    v_mfma_f32_32x32x16_bf16 v[64:79], a[12:15], a[0:3], v[64:79]
    ds_read_b64_tr_b16 a[36:37], v7 offset:20480
    ds_read_b64_tr_b16 a[38:39], v7 offset:20736
    s_waitcnt lgkmcnt(11)
    v_mfma_f32_32x32x16_bf16 v[96:111], a[28:31], a[4:7], v[96:111]
    ds_read_b128 a[0:3], v4 offset:16384
    ds_read_b64_tr_b16 a[16:17], v7 offset:50176
    ds_read_b64_tr_b16 a[18:19], v7 offset:50432
    s_waitcnt lgkmcnt(12)
    v_mfma_f32_32x32x16_bf16 v[128:143], a[4:7], a[32:35], v[128:143]
    ds_read_b64_tr_b16 a[20:21], v8 offset:21504
    ds_read_b64_tr_b16 a[22:23], v8 offset:21760
    s_waitcnt lgkmcnt(12)
    v_mfma_f32_32x32x16_bf16 v[64:79], a[24:27], a[4:7], v[64:79]
    ds_read_b64_tr_b16 a[12:13], v7 offset:21504
    ds_read_b64_tr_b16 a[14:15], v7 offset:21760
    s_waitcnt lgkmcnt(11)
    v_mfma_f32_32x32x16_bf16 v[96:111], a[40:43], a[8:11], v[96:111]
    ds_read_b128 a[4:7], v5 offset:16384
    ds_read_b64_tr_b16 a[28:29], v7 offset:51200
    ds_read_b64_tr_b16 a[30:31], v7 offset:51456
    s_waitcnt lgkmcnt(12)
    v_mfma_f32_32x32x16_bf16 v[128:143], a[8:11], a[44:47], v[128:143]
    ds_read_b64_tr_b16 a[32:33], v8 offset:22528
    ds_read_b64_tr_b16 a[34:35], v8 offset:22784
    s_waitcnt lgkmcnt(12)
    v_mfma_f32_32x32x16_bf16 v[64:79], a[36:39], a[8:11], v[64:79]
    ds_read_b64_tr_b16 a[24:25], v7 offset:22528
    ds_read_b64_tr_b16 a[26:27], v7 offset:22784
    s_waitcnt lgkmcnt(11)
    v_mfma_f32_32x32x16_bf16 v[96:111], a[16:19], a[0:3], v[96:111]
    ds_read_b128 a[8:11], v6 offset:16384
    ds_read_b64_tr_b16 a[40:41], v7 offset:52224
    ds_read_b64_tr_b16 a[42:43], v7 offset:52480
    s_waitcnt lgkmcnt(12)
    v_mfma_f32_32x32x16_bf16 v[128:143], a[0:3], a[20:23], v[128:143]
    ds_read_b64_tr_b16 a[44:45], v8 offset:23552
    ds_read_b64_tr_b16 a[46:47], v8 offset:23808
    s_waitcnt lgkmcnt(12)
    v_mfma_f32_32x32x16_bf16 v[64:79], a[12:15], a[0:3], v[64:79]
    ds_read_b64_tr_b16 a[36:37], v7 offset:23552
    ds_read_b64_tr_b16 a[38:39], v7 offset:23808
    s_waitcnt lgkmcnt(11)
    v_mfma_f32_32x32x16_bf16 v[96:111], a[28:31], a[4:7], v[96:111]
    s_waitcnt lgkmcnt(6)
    s_barrier
    ds_read_b128 a[0:3], v3 offset:32768
    ds_read_b64_tr_b16 a[16:17], v7 offset:53248
    ds_read_b64_tr_b16 a[18:19], v7 offset:53504
    v_mfma_f32_32x32x16_bf16 v[128:143], a[4:7], a[32:35], v[128:143]
    ds_read_b64_tr_b16 a[20:21], v8 offset:24576
    ds_read_b64_tr_b16 a[22:23], v8 offset:24832
    v_mfma_f32_32x32x16_bf16 v[64:79], a[24:27], a[4:7], v[64:79]
    ds_read_b64_tr_b16 a[12:13], v7 offset:24576
    ds_read_b64_tr_b16 a[14:15], v7 offset:24832
    s_waitcnt lgkmcnt(11)
    v_mfma_f32_32x32x16_bf16 v[96:111], a[40:43], a[8:11], v[96:111]
    ds_read_b128 a[4:7], v4 offset:32768
    ds_read_b64_tr_b16 a[28:29], v7 offset:54272
    ds_read_b64_tr_b16 a[30:31], v7 offset:54528
    s_waitcnt lgkmcnt(12)
    v_mfma_f32_32x32x16_bf16 v[128:143], a[8:11], a[44:47], v[128:143]
    ds_read_b64_tr_b16 a[32:33], v8 offset:25600
    ds_read_b64_tr_b16 a[34:35], v8 offset:25856
    s_waitcnt lgkmcnt(12)
    v_mfma_f32_32x32x16_bf16 v[64:79], a[36:39], a[8:11], v[64:79]
    ds_read_b64_tr_b16 a[24:25], v7 offset:25600
    ds_read_b64_tr_b16 a[26:27], v7 offset:25856
    s_waitcnt lgkmcnt(11)
    v_mfma_f32_32x32x16_bf16 v[96:111], a[16:19], a[0:3], v[96:111]
    ds_read_b128 a[8:11], v5 offset:32768
    ds_read_b64_tr_b16 a[40:41], v7 offset:55296
    ds_read_b64_tr_b16 a[42:43], v7 offset:55552
    s_waitcnt lgkmcnt(12)
    v_mfma_f32_32x32x16_bf16 v[128:143], a[0:3], a[20:23], v[128:143]
    ds_read_b64_tr_b16 a[44:45], v8 offset:26624
    ds_read_b64_tr_b16 a[46:47], v8 offset:26880
    s_waitcnt lgkmcnt(12)
    v_mfma_f32_32x32x16_bf16 v[64:79], a[12:15], a[0:3], v[64:79]
    ds_read_b64_tr_b16 a[36:37], v7 offset:26624
    ds_read_b64_tr_b16 a[38:39], v7 offset:26880
    s_waitcnt lgkmcnt(11)
    v_mfma_f32_32x32x16_bf16 v[96:111], a[28:31], a[4:7], v[96:111]
    ds_read_b128 a[0:3], v6 offset:32768
    ds_read_b64_tr_b16 a[16:17], v7 offset:56320
    ds_read_b64_tr_b16 a[18:19], v7 offset:56576
    s_waitcnt lgkmcnt(12)
    v_mfma_f32_32x32x16_bf16 v[128:143], a[4:7], a[32:35], v[128:143]
    ds_read_b64_tr_b16 a[20:21], v8 offset:27648
    ds_read_b64_tr_b16 a[22:23], v8 offset:27904
    s_waitcnt lgkmcnt(12)
    v_mfma_f32_32x32x16_bf16 v[64:79], a[24:27], a[4:7], v[64:79]
    ds_read_b64_tr_b16 a[12:13], v7 offset:27648
    ds_read_b64_tr_b16 a[14:15], v7 offset:27904
    s_waitcnt lgkmcnt(11)
    v_mfma_f32_32x32x16_bf16 v[96:111], a[40:43], a[8:11], v[96:111]
    s_waitcnt lgkmcnt(6)
    s_barrier
    ds_read_b128 a[4:7], v3 offset:49152
    ds_read_b64_tr_b16 a[28:29], v7 offset:28672
    ds_read_b64_tr_b16 a[30:31], v7 offset:28928
    v_mfma_f32_32x32x16_bf16 v[128:143], a[8:11], a[44:47], v[128:143]
    ds_read_b64_tr_b16 a[32:33], v8 offset:0
    ds_read_b64_tr_b16 a[34:35], v8 offset:256
    v_mfma_f32_32x32x16_bf16 v[64:79], a[36:39], a[8:11], v[64:79]
    ds_read_b64_tr_b16 a[24:25], v7 offset:0
    ds_read_b64_tr_b16 a[26:27], v7 offset:256
    s_waitcnt lgkmcnt(11)
    v_mfma_f32_32x32x16_bf16 v[96:111], a[16:19], a[0:3], v[96:111]
    ds_read_b128 a[8:11], v4 offset:49152
    ds_read_b64_tr_b16 a[40:41], v7 offset:29696
    ds_read_b64_tr_b16 a[42:43], v7 offset:29952
    s_waitcnt lgkmcnt(12)
    v_mfma_f32_32x32x16_bf16 v[128:143], a[0:3], a[20:23], v[128:143]
    ds_read_b64_tr_b16 a[44:45], v8 offset:1024
    ds_read_b64_tr_b16 a[46:47], v8 offset:1280
    s_waitcnt lgkmcnt(12)
    v_mfma_f32_32x32x16_bf16 v[64:79], a[12:15], a[0:3], v[64:79]
    ds_read_b64_tr_b16 a[36:37], v7 offset:1024
    ds_read_b64_tr_b16 a[38:39], v7 offset:1280
    s_waitcnt lgkmcnt(11)
    v_mfma_f32_32x32x16_bf16 v[112:127], a[28:31], a[4:7], 0
    ds_read_b128 a[0:3], v5 offset:49152
    ds_read_b64_tr_b16 a[16:17], v7 offset:30720
    ds_read_b64_tr_b16 a[18:19], v7 offset:30976
    s_waitcnt vmcnt(0)
    s_waitcnt lgkmcnt(12)
    v_mfma_f32_32x32x16_bf16 v[144:159], a[4:7], a[32:35], 0
    ds_read_b64_tr_b16 a[20:21], v8 offset:2048
    ds_read_b64_tr_b16 a[22:23], v8 offset:2304
    s_waitcnt lgkmcnt(12)
    v_mfma_f32_32x32x16_bf16 v[80:95], a[24:27], a[4:7], 0
    ds_read_b64_tr_b16 a[12:13], v7 offset:2048
    ds_read_b64_tr_b16 a[14:15], v7 offset:2304
    s_waitcnt lgkmcnt(11)
    v_mfma_f32_32x32x16_bf16 v[112:127], a[40:43], a[8:11], v[112:127]
    ds_read_b128 a[4:7], v6 offset:49152
    ds_read_b64_tr_b16 a[28:29], v7 offset:31744
    ds_read_b64_tr_b16 a[30:31], v7 offset:32000
    v_cvt_pk_bf16_f32 v96, v96, v97
    v_cvt_pk_bf16_f32 v97, v98, v99
    v_cvt_pk_bf16_f32 v98, v100, v101
    s_waitcnt lgkmcnt(12)
    v_mfma_f32_32x32x16_bf16 v[144:159], a[8:11], a[44:47], v[144:159]
    ds_read_b64_tr_b16 a[32:33], v8 offset:3072
    ds_read_b64_tr_b16 a[34:35], v8 offset:3328
    v_cvt_pk_bf16_f32 v99, v102, v103
    v_cvt_pk_bf16_f32 v100, v104, v105
    v_cvt_pk_bf16_f32 v101, v106, v107
    s_waitcnt lgkmcnt(12)
    v_mfma_f32_32x32x16_bf16 v[80:95], a[36:39], a[8:11], v[80:95]
    ds_read_b64_tr_b16 a[24:25], v7 offset:3072
    ds_read_b64_tr_b16 a[26:27], v7 offset:3328
    v_cvt_pk_bf16_f32 v102, v108, v109
    v_cvt_pk_bf16_f32 v103, v110, v111
    v_cndmask_b32 v102, v102, v24, s[58:59]
    s_waitcnt lgkmcnt(11)
    v_mfma_f32_32x32x16_bf16 v[112:127], a[16:19], a[0:3], v[112:127]
    s_waitcnt lgkmcnt(6)
    s_barrier
    ds_read_b128 a[8:11], v3 offset:0
    ds_read_b64_tr_b16 a[40:41], v7 offset:32768
    ds_read_b64_tr_b16 a[42:43], v7 offset:33024
    v_cndmask_b32 v103, v103, v25, s[58:59]
    buffer_store_dwordx4 v[96:99], v11, s[20:23], s65 offen offset:0 sc1
    buffer_store_dwordx4 v[100:103], v11, s[20:23], s65 offen offset:1024 sc1
    v_mfma_f32_32x32x16_bf16 v[144:159], a[0:3], a[20:23], v[144:159]
    ds_read_b64_tr_b16 a[44:45], v8 offset:4096
    ds_read_b64_tr_b16 a[46:47], v8 offset:4352
    v_cvt_pk_bf16_f32 v128, v128, v129
    v_cvt_pk_bf16_f32 v129, v130, v131
    v_cvt_pk_bf16_f32 v130, v132, v133
    v_mfma_f32_32x32x16_bf16 v[80:95], a[12:15], a[0:3], v[80:95]
    ds_read_b64_tr_b16 a[36:37], v7 offset:4096
    ds_read_b64_tr_b16 a[38:39], v7 offset:4352
    v_cvt_pk_bf16_f32 v131, v134, v135
    v_cvt_pk_bf16_f32 v132, v136, v137
    v_cvt_pk_bf16_f32 v133, v138, v139
    s_waitcnt lgkmcnt(11)
    v_mfma_f32_32x32x16_bf16 v[112:127], a[28:31], a[4:7], v[112:127]
    ds_read_b128 a[0:3], v4 offset:0
    ds_read_b64_tr_b16 a[16:17], v7 offset:33792
    ds_read_b64_tr_b16 a[18:19], v7 offset:34048
    v_cvt_pk_bf16_f32 v134, v140, v141
    v_cvt_pk_bf16_f32 v135, v142, v143
    v_cndmask_b32 v128, v128, v16, s[60:61]
    s_waitcnt lgkmcnt(12)
    v_mfma_f32_32x32x16_bf16 v[144:159], a[4:7], a[32:35], v[144:159]
L_pad2:
    s_cbranch_execz L_padret2
    ds_read_b64_tr_b16 a[20:21], v8 offset:5120
    ds_read_b64_tr_b16 a[22:23], v8 offset:5376
    v_cndmask_b32 v129, v129, v16, s[60:61]
    v_cndmask_b32 v130, v130, v16, s[60:61]
    v_cndmask_b32 v131, v131, v16, s[60:61]
    s_waitcnt lgkmcnt(12)
    v_mfma_f32_32x32x16_bf16 v[80:95], a[24:27], a[4:7], v[80:95]
    ds_read_b64_tr_b16 a[12:13], v7 offset:5120
    ds_read_b64_tr_b16 a[14:15], v7 offset:5376
    v_cndmask_b32 v132, v132, v16, s[60:61]
    v_cndmask_b32 v133, v133, v16, s[60:61]
    v_cndmask_b32 v134, v134, v16, s[60:61]
    s_waitcnt lgkmcnt(11)
    v_mfma_f32_32x32x16_bf16 v[112:127], a[40:43], a[8:11], v[112:127]
    ds_read_b128 a[4:7], v5 offset:0
    ds_read_b64_tr_b16 a[28:29], v7 offset:34816
    ds_read_b64_tr_b16 a[30:31], v7 offset:35072
    v_cndmask_b32 v135, v135, v16, s[60:61]
    buffer_store_dwordx4 v[128:131], v2, s[20:23], s65 offen offset:2048 sc1
    buffer_store_dwordx4 v[132:135], v2, s[20:23], s65 offen offset:3072 sc1
    s_waitcnt lgkmcnt(12)
    v_mfma_f32_32x32x16_bf16 v[144:159], a[8:11], a[44:47], v[144:159]
    ds_read_b64_tr_b16 a[32:33], v8 offset:6144
    ds_read_b64_tr_b16 a[34:35], v8 offset:6400
    v_pk_mul_f32 v[64:65], v[64:65], s[66:67] op_sel_hi:[1,0]
    v_pk_mul_f32 v[66:67], v[66:67], s[66:67] op_sel_hi:[1,0]
    v_pk_mul_f32 v[68:69], v[68:69], s[66:67] op_sel_hi:[1,0]
    s_waitcnt lgkmcnt(12)
    v_mfma_f32_32x32x16_bf16 v[80:95], a[36:39], a[8:11], v[80:95]
    ds_read_b64_tr_b16 a[24:25], v7 offset:6144
    ds_read_b64_tr_b16 a[26:27], v7 offset:6400
    v_pk_mul_f32 v[70:71], v[70:71], s[66:67] op_sel_hi:[1,0]
    v_pk_mul_f32 v[72:73], v[72:73], s[66:67] op_sel_hi:[1,0]
    v_pk_mul_f32 v[74:75], v[74:75], s[66:67] op_sel_hi:[1,0]
    s_waitcnt lgkmcnt(11)
    v_mfma_f32_32x32x16_bf16 v[112:127], a[16:19], a[0:3], v[112:127]
    ds_read_b128 a[8:11], v6 offset:0
    ds_read_b64_tr_b16 a[40:41], v7 offset:35840
    ds_read_b64_tr_b16 a[42:43], v7 offset:36096
    v_pk_mul_f32 v[76:77], v[76:77], s[66:67] op_sel_hi:[1,0]
    v_pk_mul_f32 v[78:79], v[78:79], s[66:67] op_sel_hi:[1,0]
    v_cvt_pk_bf16_f32 v32, v64, v65
    s_waitcnt lgkmcnt(12)
    v_mfma_f32_32x32x16_bf16 v[144:159], a[0:3], a[20:23], v[144:159]
    ds_read_b64_tr_b16 a[44:45], v8 offset:7168
    ds_read_b64_tr_b16 a[46:47], v8 offset:7424
    v_cvt_pk_bf16_f32 v33, v66, v67
    v_cvt_pk_bf16_f32 v34, v68, v69
    v_cvt_pk_bf16_f32 v35, v70, v71
    s_waitcnt lgkmcnt(12)
    v_mfma_f32_32x32x16_bf16 v[80:95], a[12:15], a[0:3], v[80:95]
    ds_read_b64_tr_b16 a[36:37], v7 offset:7168
    ds_read_b64_tr_b16 a[38:39], v7 offset:7424
    v_cvt_pk_bf16_f32 v36, v72, v73
    v_cvt_pk_bf16_f32 v37, v74, v75
    v_cvt_pk_bf16_f32 v38, v76, v77
    s_waitcnt lgkmcnt(11)
    v_mfma_f32_32x32x16_bf16 v[112:127], a[28:31], a[4:7], v[112:127]
    s_waitcnt lgkmcnt(6)
    s_barrier
    ds_read_b128 a[0:3], v3 offset:16384
    ds_read_b64_tr_b16 a[16:17], v7 offset:36864
    ds_read_b64_tr_b16 a[18:19], v7 offset:37120
    v_cvt_pk_bf16_f32 v39, v78, v79
    v_cndmask_b32 v38, v38, 0, s[58:59]
    v_cndmask_b32 v39, v39, 0, s[58:59]
    v_mfma_f32_32x32x16_bf16 v[144:159], a[4:7], a[32:35], v[144:159]
    ds_read_b64_tr_b16 a[20:21], v8 offset:8192
    ds_read_b64_tr_b16 a[22:23], v8 offset:8448
    v_mfma_f32_32x32x16_bf16 v[48:63], v[96:99], v[32:35], 0
    v_mfma_f32_32x32x16_bf16 v[80:95], a[24:27], a[4:7], v[80:95]
    ds_read_b64_tr_b16 a[12:13], v7 offset:8192
    ds_read_b64_tr_b16 a[14:15], v7 offset:8448
    v_mfma_f32_32x32x16_bf16 v[48:63], v[100:103], v[36:39], v[48:63]
    s_waitcnt lgkmcnt(11)
    v_mfma_f32_32x32x16_bf16 v[112:127], a[40:43], a[8:11], v[112:127]
    ds_read_b128 a[4:7], v4 offset:16384
    ds_read_b64_tr_b16 a[28:29], v7 offset:37888
    ds_read_b64_tr_b16 a[30:31], v7 offset:38144
    s_waitcnt lgkmcnt(12)
    v_mfma_f32_32x32x16_bf16 v[144:159], a[8:11], a[44:47], v[144:159]
    ds_read_b64_tr_b16 a[32:33], v8 offset:9216
    ds_read_b64_tr_b16 a[34:35], v8 offset:9472
    s_waitcnt lgkmcnt(12)
    v_mfma_f32_32x32x16_bf16 v[80:95], a[36:39], a[8:11], v[80:95]
    ds_read_b64_tr_b16 a[24:25], v7 offset:9216
    ds_read_b64_tr_b16 a[26:27], v7 offset:9472
    s_waitcnt lgkmcnt(11)
    v_mfma_f32_32x32x16_bf16 v[112:127], a[16:19], a[0:3], v[112:127]
    ds_read_b128 a[8:11], v5 offset:16384
    ds_read_b64_tr_b16 a[40:41], v7 offset:38912
    ds_read_b64_tr_b16 a[42:43], v7 offset:39168
    v_max3_f32 v20, v48, v49, v50
    v_max3_f32 v20, v20, v51, v52
    s_waitcnt lgkmcnt(12)
    v_mfma_f32_32x32x16_bf16 v[144:159], a[0:3], a[20:23], v[144:159]
    ds_read_b64_tr_b16 a[44:45], v8 offset:10240
    ds_read_b64_tr_b16 a[46:47], v8 offset:10496
    v_max3_f32 v20, v20, v53, v54
    v_max3_f32 v20, v20, v55, v56
    v_max3_f32 v20, v20, v57, v58
    s_waitcnt lgkmcnt(12)
    v_mfma_f32_32x32x16_bf16 v[80:95], a[12:15], a[0:3], v[80:95]
    ds_read_b64_tr_b16 a[36:37], v7 offset:10240
    ds_read_b64_tr_b16 a[38:39], v7 offset:10496
    v_max3_f32 v20, v20, v59, v60
    v_max3_f32 v20, v20, v61, v62
    v_max_f32 v20, v20, v63
    s_waitcnt lgkmcnt(11)
    v_mfma_f32_32x32x16_bf16 v[112:127], a[28:31], a[4:7], v[112:127]
    ds_read_b128 a[0:3], v6 offset:16384
    ds_read_b64_tr_b16 a[16:17], v7 offset:39936
    ds_read_b64_tr_b16 a[18:19], v7 offset:40192
    v_mov_b32 v22, v20
    s_nop 1
    v_permlane32_swap_b32 v20, v22
    s_waitcnt lgkmcnt(12)
    v_mfma_f32_32x32x16_bf16 v[144:159], a[4:7], a[32:35], v[144:159]
    ds_read_b64_tr_b16 a[20:21], v8 offset:11264
    ds_read_b64_tr_b16 a[22:23], v8 offset:11520
    v_max_f32 v20, v20, v22
    v_cvt_pk_bf16_f32 v20, -v20, 0
    v_cndmask_b32 v38, v38, v20, s[58:59]
    s_waitcnt lgkmcnt(12)
    v_mfma_f32_32x32x16_bf16 v[80:95], a[24:27], a[4:7], v[80:95]
    ds_read_b64_tr_b16 a[12:13], v7 offset:11264
    ds_read_b64_tr_b16 a[14:15], v7 offset:11520
    s_waitcnt lgkmcnt(11)
    v_mfma_f32_32x32x16_bf16 v[112:127], a[40:43], a[8:11], v[112:127]
    s_waitcnt lgkmcnt(6)
    s_barrier
    ds_read_b128 a[4:7], v3 offset:32768
    ds_read_b64_tr_b16 a[28:29], v7 offset:40960
    ds_read_b64_tr_b16 a[30:31], v7 offset:41216
    v_mfma_f32_32x32x16_bf16 v[144:159], a[8:11], a[44:47], v[144:159]
    ds_read_b64_tr_b16 a[32:33], v8 offset:12288
    ds_read_b64_tr_b16 a[34:35], v8 offset:12544
    v_mfma_f32_32x32x16_bf16 v[80:95], a[36:39], a[8:11], v[80:95]
    ds_read_b64_tr_b16 a[24:25], v7 offset:12288
    ds_read_b64_tr_b16 a[26:27], v7 offset:12544
    s_waitcnt lgkmcnt(11)
    v_mfma_f32_32x32x16_bf16 v[112:127], a[16:19], a[0:3], v[112:127]
    ds_read_b128 a[8:11], v4 offset:32768
    ds_read_b64_tr_b16 a[40:41], v7 offset:41984
    ds_read_b64_tr_b16 a[42:43], v7 offset:42240
    s_waitcnt lgkmcnt(12)
    v_mfma_f32_32x32x16_bf16 v[144:159], a[0:3], a[20:23], v[144:159]
    ds_read_b64_tr_b16 a[44:45], v8 offset:13312
    ds_read_b64_tr_b16 a[46:47], v8 offset:13568
    s_waitcnt lgkmcnt(12)
    v_mfma_f32_32x32x16_bf16 v[80:95], a[12:15], a[0:3], v[80:95]
    ds_read_b64_tr_b16 a[36:37], v7 offset:13312
    ds_read_b64_tr_b16 a[38:39], v7 offset:13568
    s_waitcnt lgkmcnt(11)
    v_mfma_f32_32x32x16_bf16 v[112:127], a[28:31], a[4:7], v[112:127]
    ds_read_b128 a[0:3], v5 offset:32768
    ds_read_b64_tr_b16 a[16:17], v7 offset:43008
    ds_read_b64_tr_b16 a[18:19], v7 offset:43264
    s_waitcnt lgkmcnt(12)
    v_mfma_f32_32x32x16_bf16 v[144:159], a[4:7], a[32:35], v[144:159]
    ds_read_b64_tr_b16 a[20:21], v8 offset:14336
    ds_read_b64_tr_b16 a[22:23], v8 offset:14592
    s_waitcnt lgkmcnt(12)
    v_mfma_f32_32x32x16_bf16 v[80:95], a[24:27], a[4:7], v[80:95]
    ds_read_b64_tr_b16 a[12:13], v7 offset:14336
    ds_read_b64_tr_b16 a[14:15], v7 offset:14592
    s_waitcnt lgkmcnt(11)
    v_mfma_f32_32x32x16_bf16 v[112:127], a[40:43], a[8:11], v[112:127]
    ds_read_b128 a[4:7], v6 offset:32768
    ds_read_b64_tr_b16 a[28:29], v7 offset:44032
    ds_read_b64_tr_b16 a[30:31], v7 offset:44288
    s_waitcnt lgkmcnt(12)
    v_mfma_f32_32x32x16_bf16 v[144:159], a[8:11], a[44:47], v[144:159]
    ds_read_b64_tr_b16 a[32:33], v8 offset:15360
    ds_read_b64_tr_b16 a[34:35], v8 offset:15616
    s_waitcnt lgkmcnt(12)
    v_mfma_f32_32x32x16_bf16 v[80:95], a[36:39], a[8:11], v[80:95]
    ds_read_b64_tr_b16 a[24:25], v7 offset:15360
    ds_read_b64_tr_b16 a[26:27], v7 offset:15616
    s_waitcnt lgkmcnt(11)
    v_mfma_f32_32x32x16_bf16 v[112:127], a[16:19], a[0:3], v[112:127]
    s_waitcnt lgkmcnt(6)
    s_barrier
    ds_read_b128 a[8:11], v3 offset:49152
    ds_read_b64_tr_b16 a[40:41], v7 offset:45056
    ds_read_b64_tr_b16 a[42:43], v7 offset:45312
    v_mfma_f32_32x32x16_bf16 v[144:159], a[0:3], a[20:23], v[144:159]
    ds_read_b64_tr_b16 a[44:45], v8 offset:16384
    ds_read_b64_tr_b16 a[46:47], v8 offset:16640
    v_mfma_f32_32x32x16_bf16 v[80:95], a[12:15], a[0:3], v[80:95]
    ds_read_b64_tr_b16 a[36:37], v7 offset:16384
    ds_read_b64_tr_b16 a[38:39], v7 offset:16640
    s_waitcnt vmcnt(0)
    buffer_store_dword v17, v13, s[28:31], 0 offen sc1
    s_waitcnt lgkmcnt(11)
    v_mfma_f32_32x32x16_bf16 v[112:127], a[28:31], a[4:7], v[112:127]
    ds_read_b128 a[0:3], v4 offset:49152
    ds_read_b64_tr_b16 a[16:17], v7 offset:46080
    ds_read_b64_tr_b16 a[18:19], v7 offset:46336
    s_waitcnt lgkmcnt(12)
    v_mfma_f32_32x32x16_bf16 v[144:159], a[4:7], a[32:35], v[144:159]
    ds_read_b64_tr_b16 a[20:21], v8 offset:17408
    ds_read_b64_tr_b16 a[22:23], v8 offset:17664
    s_waitcnt lgkmcnt(12)
    v_mfma_f32_32x32x16_bf16 v[80:95], a[24:27], a[4:7], v[80:95]
    ds_read_b64_tr_b16 a[12:13], v7 offset:17408
    ds_read_b64_tr_b16 a[14:15], v7 offset:17664
    s_waitcnt lgkmcnt(11)
    v_mfma_f32_32x32x16_bf16 v[112:127], a[40:43], a[8:11], v[112:127]
    ds_read_b128 a[4:7], v5 offset:49152
    ds_read_b64_tr_b16 a[28:29], v7 offset:47104
    ds_read_b64_tr_b16 a[30:31], v7 offset:47360
    s_waitcnt lgkmcnt(12)
    v_mfma_f32_32x32x16_bf16 v[144:159], a[8:11], a[44:47], v[144:159]
    ds_read_b64_tr_b16 a[32:33], v8 offset:18432
    ds_read_b64_tr_b16 a[34:35], v8 offset:18688
    s_waitcnt lgkmcnt(12)
    v_mfma_f32_32x32x16_bf16 v[80:95], a[36:39], a[8:11], v[80:95]
    ds_read_b64_tr_b16 a[24:25], v7 offset:18432
    ds_read_b64_tr_b16 a[26:27], v7 offset:18688
    s_waitcnt lgkmcnt(11)
    v_mfma_f32_32x32x16_bf16 v[112:127], a[16:19], a[0:3], v[112:127]
    ds_read_b128 a[8:11], v6 offset:49152
    ds_read_b64_tr_b16 a[40:41], v7 offset:48128
    ds_read_b64_tr_b16 a[42:43], v7 offset:48384
    s_waitcnt lgkmcnt(12)
    v_mfma_f32_32x32x16_bf16 v[144:159], a[0:3], a[20:23], v[144:159]
    ds_read_b64_tr_b16 a[44:45], v8 offset:19456
    ds_read_b64_tr_b16 a[46:47], v8 offset:19712
    s_waitcnt lgkmcnt(12)
    v_mfma_f32_32x32x16_bf16 v[80:95], a[12:15], a[0:3], v[80:95]
    ds_read_b64_tr_b16 a[36:37], v7 offset:19456
    ds_read_b64_tr_b16 a[38:39], v7 offset:19712
    s_waitcnt lgkmcnt(11)
    v_mfma_f32_32x32x16_bf16 v[112:127], a[28:31], a[4:7], v[112:127]
    s_waitcnt lgkmcnt(6)
    s_barrier
    ds_read_b128 a[0:3], v3 offset:0
    ds_read_b64_tr_b16 a[16:17], v7 offset:49152
    ds_read_b64_tr_b16 a[18:19], v7 offset:49408
    v_mfma_f32_32x32x16_bf16 v[144:159], a[4:7], a[32:35], v[144:159]
    ds_read_b64_tr_b16 a[20:21], v8 offset:20480
    ds_read_b64_tr_b16 a[22:23], v8 offset:20736
    v_mfma_f32_32x32x16_bf16 v[80:95], a[24:27], a[4:7], v[80:95]
    ds_read_b64_tr_b16 a[12:13], v7 offset:20480
    ds_read_b64_tr_b16 a[14:15], v7 offset:20736
    s_waitcnt lgkmcnt(11)
    v_mfma_f32_32x32x16_bf16 v[112:127], a[40:43], a[8:11], v[112:127]
    ds_read_b128 a[4:7], v4 offset:0
    ds_read_b64_tr_b16 a[28:29], v7 offset:50176
    ds_read_b64_tr_b16 a[30:31], v7 offset:50432
    s_waitcnt lgkmcnt(12)
    v_mfma_f32_32x32x16_bf16 v[144:159], a[8:11], a[44:47], v[144:159]
    ds_read_b64_tr_b16 a[32:33], v8 offset:21504
    ds_read_b64_tr_b16 a[34:35], v8 offset:21760
    s_waitcnt lgkmcnt(12)
    v_mfma_f32_32x32x16_bf16 v[80:95], a[36:39], a[8:11], v[80:95]
    ds_read_b64_tr_b16 a[24:25], v7 offset:21504
    ds_read_b64_tr_b16 a[26:27], v7 offset:21760
    s_waitcnt lgkmcnt(11)
    v_mfma_f32_32x32x16_bf16 v[112:127], a[16:19], a[0:3], v[112:127]
    ds_read_b128 a[8:11], v5 offset:0
    ds_read_b64_tr_b16 a[40:41], v7 offset:51200
    ds_read_b64_tr_b16 a[42:43], v7 offset:51456
    s_waitcnt lgkmcnt(12)
    v_mfma_f32_32x32x16_bf16 v[144:159], a[0:3], a[20:23], v[144:159]
    ds_read_b64_tr_b16 a[44:45], v8 offset:22528
    ds_read_b64_tr_b16 a[46:47], v8 offset:22784
    s_waitcnt lgkmcnt(12)
    v_mfma_f32_32x32x16_bf16 v[80:95], a[12:15], a[0:3], v[80:95]
    ds_read_b64_tr_b16 a[36:37], v7 offset:22528
    ds_read_b64_tr_b16 a[38:39], v7 offset:22784
    s_waitcnt lgkmcnt(11)
    v_mfma_f32_32x32x16_bf16 v[112:127], a[28:31], a[4:7], v[112:127]
    ds_read_b128 a[0:3], v6 offset:0
    ds_read_b64_tr_b16 a[16:17], v7 offset:52224
    ds_read_b64_tr_b16 a[18:19], v7 offset:52480
    s_waitcnt lgkmcnt(12)
    v_mfma_f32_32x32x16_bf16 v[144:159], a[4:7], a[32:35], v[144:159]
    ds_read_b64_tr_b16 a[20:21], v8 offset:23552
    ds_read_b64_tr_b16 a[22:23], v8 offset:23808
    s_waitcnt lgkmcnt(12)
    v_mfma_f32_32x32x16_bf16 v[80:95], a[24:27], a[4:7], v[80:95]
    ds_read_b64_tr_b16 a[12:13], v7 offset:23552
    ds_read_b64_tr_b16 a[14:15], v7 offset:23808
    s_waitcnt lgkmcnt(11)
    v_mfma_f32_32x32x16_bf16 v[112:127], a[40:43], a[8:11], v[112:127]
    s_waitcnt lgkmcnt(6)
    s_barrier
    ds_read_b128 a[4:7], v3 offset:16384
    ds_read_b64_tr_b16 a[28:29], v7 offset:53248
    ds_read_b64_tr_b16 a[30:31], v7 offset:53504
    v_mfma_f32_32x32x16_bf16 v[144:159], a[8:11], a[44:47], v[144:159]
    ds_read_b64_tr_b16 a[32:33], v8 offset:24576
    ds_read_b64_tr_b16 a[34:35], v8 offset:24832
    v_mfma_f32_32x32x16_bf16 v[80:95], a[36:39], a[8:11], v[80:95]
    ds_read_b64_tr_b16 a[24:25], v7 offset:24576
    ds_read_b64_tr_b16 a[26:27], v7 offset:24832
    s_waitcnt lgkmcnt(11)
    v_mfma_f32_32x32x16_bf16 v[112:127], a[16:19], a[0:3], v[112:127]
    ds_read_b128 a[8:11], v4 offset:16384
    ds_read_b64_tr_b16 a[40:41], v7 offset:54272
    ds_read_b64_tr_b16 a[42:43], v7 offset:54528
    s_waitcnt lgkmcnt(12)
    v_mfma_f32_32x32x16_bf16 v[144:159], a[0:3], a[20:23], v[144:159]
    ds_read_b64_tr_b16 a[44:45], v8 offset:25600
    ds_read_b64_tr_b16 a[46:47], v8 offset:25856
    s_waitcnt lgkmcnt(12)
    v_mfma_f32_32x32x16_bf16 v[80:95], a[12:15], a[0:3], v[80:95]
    ds_read_b64_tr_b16 a[36:37], v7 offset:25600
    ds_read_b64_tr_b16 a[38:39], v7 offset:25856
    s_waitcnt lgkmcnt(11)
    v_mfma_f32_32x32x16_bf16 v[112:127], a[28:31], a[4:7], v[112:127]
    ds_read_b128 a[0:3], v5 offset:16384
    ds_read_b64_tr_b16 a[16:17], v7 offset:55296
    ds_read_b64_tr_b16 a[18:19], v7 offset:55552
    s_waitcnt lgkmcnt(12)
    v_mfma_f32_32x32x16_bf16 v[144:159], a[4:7], a[32:35], v[144:159]
    ds_read_b64_tr_b16 a[20:21], v8 offset:26624
    ds_read_b64_tr_b16 a[22:23], v8 offset:26880
    s_waitcnt lgkmcnt(12)
    v_mfma_f32_32x32x16_bf16 v[80:95], a[24:27], a[4:7], v[80:95]
    ds_read_b64_tr_b16 a[12:13], v7 offset:26624
    ds_read_b64_tr_b16 a[14:15], v7 offset:26880
    s_waitcnt lgkmcnt(11)
    v_mfma_f32_32x32x16_bf16 v[112:127], a[40:43], a[8:11], v[112:127]
    ds_read_b128 a[4:7], v6 offset:16384
    ds_read_b64_tr_b16 a[28:29], v7 offset:56320
    ds_read_b64_tr_b16 a[30:31], v7 offset:56576
    s_waitcnt lgkmcnt(12)
    v_mfma_f32_32x32x16_bf16 v[144:159], a[8:11], a[44:47], v[144:159]
    ds_read_b64_tr_b16 a[32:33], v8 offset:27648
    ds_read_b64_tr_b16 a[34:35], v8 offset:27904
    s_waitcnt lgkmcnt(12)
    v_mfma_f32_32x32x16_bf16 v[80:95], a[36:39], a[8:11], v[80:95]
    ds_read_b64_tr_b16 a[24:25], v7 offset:27648
    ds_read_b64_tr_b16 a[26:27], v7 offset:27904
    s_waitcnt lgkmcnt(7)
    v_mfma_f32_32x32x16_bf16 v[80:95], a[12:15], a[0:3], v[80:95]
    ds_write_b128 v9, v[96:99] offset:0
    ds_write_b128 v9, v[100:103] offset:1024
    s_waitcnt lgkmcnt(2)
    v_mfma_f32_32x32x16_bf16 v[80:95], a[24:27], a[4:7], v[80:95]
    ds_write_b128 v10, v[128:131] offset:2048
    ds_write_b128 v10, v[132:135] offset:3072
    v_mfma_f32_32x32x16_bf16 v[112:127], a[16:19], a[0:3], v[112:127]
    ds_read_b128 a[48:51], v26 offset:0
    ds_read_b128 a[52:55], v26 offset:1024
    v_mfma_f32_32x32x16_bf16 v[144:159], a[0:3], a[20:23], v[144:159]
    ds_read_b128 a[56:59], v26 offset:2048
    ds_read_b128 a[60:63], v26 offset:3072
    s_nop 2
    v_mfma_f32_32x32x16_bf16 v[112:127], a[28:31], a[4:7], v[112:127]
    v_pk_mul_f32 v[80:81], v[80:81], s[66:67] op_sel_hi:[1,0]
    v_pk_mul_f32 v[82:83], v[82:83], s[66:67] op_sel_hi:[1,0]
    v_pk_mul_f32 v[84:85], v[84:85], s[66:67] op_sel_hi:[1,0]
    v_pk_mul_f32 v[86:87], v[86:87], s[66:67] op_sel_hi:[1,0]
    v_pk_mul_f32 v[88:89], v[88:89], s[66:67] op_sel_hi:[1,0]
    v_pk_mul_f32 v[90:91], v[90:91], s[66:67] op_sel_hi:[1,0]
    v_mfma_f32_32x32x16_bf16 v[144:159], a[4:7], a[32:35], v[144:159]
    v_pk_mul_f32 v[92:93], v[92:93], s[66:67] op_sel_hi:[1,0]
    v_pk_mul_f32 v[94:95], v[94:95], s[66:67] op_sel_hi:[1,0]
    v_cvt_pk_bf16_f32 v40, v80, v81
    v_cvt_pk_bf16_f32 v41, v82, v83
    v_cvt_pk_bf16_f32 v42, v84, v85
    v_cvt_pk_bf16_f32 v43, v86, v87
    v_cvt_pk_bf16_f32 v44, v88, v89
    v_cvt_pk_bf16_f32 v45, v90, v91
    s_waitcnt lgkmcnt(0)
    v_mfma_f32_32x32x16_bf16 v[64:79], a[48:51], v[32:35], 0
    v_cvt_pk_bf16_f32 v46, v92, v93
    v_cvt_pk_bf16_f32 v47, v94, v95
    v_cndmask_b32 v46, v46, 0, s[58:59]
    v_cndmask_b32 v47, v47, 0, s[58:59]
    v_mfma_f32_32x32x16_bf16 v[64:79], a[52:55], v[36:39], v[64:79]
    v_cvt_pk_bf16_f32 v112, v112, v113
    v_cvt_pk_bf16_f32 v113, v114, v115
    v_cvt_pk_bf16_f32 v114, v116, v117
    v_cvt_pk_bf16_f32 v115, v118, v119
    v_mfma_f32_32x32x16_bf16 v[48:63], v[96:99], v[40:43], 0
    v_cvt_pk_bf16_f32 v116, v120, v121
    v_cvt_pk_bf16_f32 v117, v122, v123
    v_cvt_pk_bf16_f32 v118, v124, v125
    v_cvt_pk_bf16_f32 v119, v126, v127
    v_cndmask_b32 v118, v118, v24, s[58:59]
    v_cndmask_b32 v119, v119, v25, s[58:59]
    ds_write_b128 v9, v[112:115] offset:16384
    ds_write_b128 v9, v[116:119] offset:17408
    v_mfma_f32_32x32x16_bf16 v[48:63], v[100:103], v[44:47], v[48:63]
    v_cvt_pk_bf16_f32 v144, v144, v145
    v_cvt_pk_bf16_f32 v145, v146, v147
    v_cvt_pk_bf16_f32 v146, v148, v149
    v_cvt_pk_bf16_f32 v147, v150, v151
    v_cvt_pk_bf16_f32 v148, v152, v153
    v_cvt_pk_bf16_f32 v149, v154, v155
    v_cvt_pk_bf16_f32 v150, v156, v157
    v_cvt_pk_bf16_f32 v151, v158, v159
    v_cndmask_b32 v144, v144, v16, s[60:61]
    v_cndmask_b32 v145, v145, v16, s[60:61]
    v_cndmask_b32 v146, v146, v16, s[60:61]
    v_cndmask_b32 v147, v147, v16, s[60:61]
    v_cndmask_b32 v148, v148, v16, s[60:61]
    v_cndmask_b32 v149, v149, v16, s[60:61]
    v_cndmask_b32 v150, v150, v16, s[60:61]
    v_cndmask_b32 v151, v151, v16, s[60:61]
    ds_write_b128 v10, v[144:147] offset:18432
    ds_write_b128 v10, v[148:151] offset:19456
    v_max3_f32 v20, v48, v49, v50
    v_max3_f32 v20, v20, v51, v52
    v_max3_f32 v20, v20, v53, v54
    v_max3_f32 v20, v20, v55, v56
    v_max3_f32 v20, v20, v57, v58
    v_max3_f32 v20, v20, v59, v60
    v_max3_f32 v20, v20, v61, v62
    v_max_f32 v20, v20, v63
    v_mov_b32 v22, v20
    s_nop 1
    v_permlane32_swap_b32 v20, v22
    v_max_f32 v20, v20, v22
    v_cvt_pk_bf16_f32 v20, -v20, 0
    v_cndmask_b32 v46, v46, v20, s[58:59]
    s_waitcnt lgkmcnt(0)
    s_barrier
    ds_read_b128 a[0:3], v27 offset:0
    ds_read_b128 a[4:7], v27 offset:1024
    v_mfma_f32_32x32x16_bf16 v[80:95], a[48:51], v[40:43], 0
    v_exp_f32 v64, v64
    v_exp_f32 v65, v65
    v_exp_f32 v66, v66
    v_exp_f32 v67, v67
    v_mfma_f32_32x32x16_bf16 v[80:95], a[52:55], v[44:47], v[80:95]
    v_exp_f32 v68, v68
    v_exp_f32 v69, v69
    v_exp_f32 v70, v70
    v_exp_f32 v71, v71
    v_exp_f32 v72, v72
    v_exp_f32 v73, v73
    v_exp_f32 v74, v74
    v_exp_f32 v75, v75
    s_waitcnt lgkmcnt(0)
    v_exp_f32 v76, v76
    v_exp_f32 v77, v77
    v_exp_f32 v78, v78
    v_exp_f32 v79, v79
    v_mfma_f32_32x32x16_bf16 v[96:111], a[0:3], v[32:35], 0
    ds_read_b128 a[8:11], v27 offset:2048
    v_exp_f32 v80, v80
    v_exp_f32 v81, v81
    v_exp_f32 v82, v82
    v_exp_f32 v83, v83
    v_mfma_f32_32x32x16_bf16 v[96:111], a[4:7], v[36:39], v[96:111]
    ds_read_b128 a[12:15], v27 offset:3072
    v_exp_f32 v84, v84
    v_exp_f32 v85, v85
    v_exp_f32 v86, v86
    v_exp_f32 v87, v87
    v_smfmac_f32_32x32x32_bf16 v[160:175], a[56:59], v[64:71], v15
    v_exp_f32 v88, v88
    v_exp_f32 v89, v89
    v_exp_f32 v90, v90
    v_exp_f32 v91, v91
    v_smfmac_f32_32x32x32_bf16 v[160:175], a[60:63], v[72:79], v15
    ds_read_b128 a[48:51], v28 offset:0
    ds_read_b128 a[52:55], v28 offset:1024
    v_exp_f32 v92, v92
    v_exp_f32 v93, v93
    v_exp_f32 v94, v94
    v_exp_f32 v95, v95
    v_mfma_f32_32x32x16_bf16 v[112:127], a[0:3], v[40:43], 0
    v_exp_f32 v96, v96
    v_exp_f32 v97, v97
    v_exp_f32 v98, v98
    v_exp_f32 v99, v99
    v_mfma_f32_32x32x16_bf16 v[112:127], a[4:7], v[44:47], v[112:127]
    v_exp_f32 v100, v100
    v_exp_f32 v101, v101
    v_exp_f32 v102, v102
    v_exp_f32 v103, v103
    v_smfmac_f32_32x32x32_bf16 v[176:191], a[56:59], v[80:87], v15
    v_exp_f32 v104, v104
    v_exp_f32 v105, v105
    v_exp_f32 v106, v106
    v_exp_f32 v107, v107
    v_smfmac_f32_32x32x32_bf16 v[176:191], a[60:63], v[88:95], v15
    s_waitcnt lgkmcnt(0)
    v_exp_f32 v108, v108
    v_exp_f32 v109, v109
    v_exp_f32 v110, v110
    v_exp_f32 v111, v111
    v_mfma_f32_32x32x16_bf16 v[64:79], a[48:51], v[32:35], 0
    ds_read_b128 a[56:59], v28 offset:2048
    v_exp_f32 v112, v112
    v_exp_f32 v113, v113
    v_exp_f32 v114, v114
    v_exp_f32 v115, v115
    v_mfma_f32_32x32x16_bf16 v[64:79], a[52:55], v[36:39], v[64:79]
    ds_read_b128 a[60:63], v28 offset:3072
    v_exp_f32 v116, v116
    v_exp_f32 v117, v117
    v_exp_f32 v118, v118
    v_exp_f32 v119, v119
    v_smfmac_f32_32x32x32_bf16 v[160:175], a[8:11], v[96:103], v15
    v_exp_f32 v120, v120
    v_exp_f32 v121, v121
    v_exp_f32 v122, v122
    v_exp_f32 v123, v123
    v_smfmac_f32_32x32x32_bf16 v[160:175], a[12:15], v[104:111], v15
    ds_read_b128 a[0:3], v29 offset:0
    ds_read_b128 a[4:7], v29 offset:1024
    v_exp_f32 v124, v124
    v_exp_f32 v125, v125
    v_exp_f32 v126, v126
    v_exp_f32 v127, v127
    v_mfma_f32_32x32x16_bf16 v[80:95], a[48:51], v[40:43], 0
    v_exp_f32 v64, v64
    v_exp_f32 v65, v65
    v_exp_f32 v66, v66
    v_exp_f32 v67, v67
    v_mfma_f32_32x32x16_bf16 v[80:95], a[52:55], v[44:47], v[80:95]
    v_exp_f32 v68, v68
    v_exp_f32 v69, v69
    v_exp_f32 v70, v70
    v_exp_f32 v71, v71
    v_smfmac_f32_32x32x32_bf16 v[176:191], a[8:11], v[112:119], v15
    v_exp_f32 v72, v72
    v_exp_f32 v73, v73
    v_exp_f32 v74, v74
    v_exp_f32 v75, v75
    v_smfmac_f32_32x32x32_bf16 v[176:191], a[12:15], v[120:127], v15
    s_waitcnt lgkmcnt(0)
    v_exp_f32 v76, v76
    v_exp_f32 v77, v77
    v_exp_f32 v78, v78
    v_exp_f32 v79, v79
    v_mfma_f32_32x32x16_bf16 v[96:111], a[0:3], v[32:35], 0
    ds_read_b128 a[8:11], v29 offset:2048
    v_exp_f32 v80, v80
    v_exp_f32 v81, v81
    v_exp_f32 v82, v82
    v_exp_f32 v83, v83
    v_mfma_f32_32x32x16_bf16 v[96:111], a[4:7], v[36:39], v[96:111]
    ds_read_b128 a[12:15], v29 offset:3072
    v_exp_f32 v84, v84
    v_exp_f32 v85, v85
    v_exp_f32 v86, v86
    v_exp_f32 v87, v87
    v_smfmac_f32_32x32x32_bf16 v[160:175], a[56:59], v[64:71], v15
    v_exp_f32 v88, v88
    v_exp_f32 v89, v89
    v_exp_f32 v90, v90
    v_exp_f32 v91, v91
    v_smfmac_f32_32x32x32_bf16 v[160:175], a[60:63], v[72:79], v15
    ds_read_b128 a[48:51], v14 offset:16384
    ds_read_b128 a[52:55], v14 offset:17408
    v_exp_f32 v92, v92
    v_exp_f32 v93, v93
    v_exp_f32 v94, v94
    v_exp_f32 v95, v95
    v_mfma_f32_32x32x16_bf16 v[112:127], a[0:3], v[40:43], 0
    v_exp_f32 v96, v96
    v_exp_f32 v97, v97
    v_exp_f32 v98, v98
    v_exp_f32 v99, v99
    v_mfma_f32_32x32x16_bf16 v[112:127], a[4:7], v[44:47], v[112:127]
    v_exp_f32 v100, v100
    v_exp_f32 v101, v101
    v_exp_f32 v102, v102
    v_exp_f32 v103, v103
    v_smfmac_f32_32x32x32_bf16 v[176:191], a[56:59], v[80:87], v15
    v_exp_f32 v104, v104
    v_exp_f32 v105, v105
    v_exp_f32 v106, v106
    v_exp_f32 v107, v107
    v_smfmac_f32_32x32x32_bf16 v[176:191], a[60:63], v[88:95], v15
    s_waitcnt lgkmcnt(0)
    v_exp_f32 v108, v108
    v_exp_f32 v109, v109
    v_exp_f32 v110, v110
    v_exp_f32 v111, v111
    v_mfma_f32_32x32x16_bf16 v[64:79], a[48:51], v[32:35], 0
    ds_read_b128 a[56:59], v14 offset:18432
    v_exp_f32 v112, v112
    v_exp_f32 v113, v113
    v_exp_f32 v114, v114
    v_exp_f32 v115, v115
    v_mfma_f32_32x32x16_bf16 v[64:79], a[52:55], v[36:39], v[64:79]
    ds_read_b128 a[60:63], v14 offset:19456
    v_exp_f32 v116, v116
    v_exp_f32 v117, v117
    v_exp_f32 v118, v118
    v_exp_f32 v119, v119
    v_smfmac_f32_32x32x32_bf16 v[160:175], a[8:11], v[96:103], v15
    v_exp_f32 v120, v120
    v_exp_f32 v121, v121
    v_exp_f32 v122, v122
    v_exp_f32 v123, v123
    v_smfmac_f32_32x32x32_bf16 v[160:175], a[12:15], v[104:111], v15
    ds_read_b128 a[0:3], v14 offset:20480
    ds_read_b128 a[4:7], v14 offset:21504
    v_exp_f32 v124, v124
    v_exp_f32 v125, v125
    v_exp_f32 v126, v126
    v_exp_f32 v127, v127
    v_mfma_f32_32x32x16_bf16 v[80:95], a[48:51], v[40:43], 0
    v_exp_f32 v64, v64
    v_exp_f32 v65, v65
    v_exp_f32 v66, v66
    v_exp_f32 v67, v67
    v_mfma_f32_32x32x16_bf16 v[80:95], a[52:55], v[44:47], v[80:95]
    v_exp_f32 v68, v68
    v_exp_f32 v69, v69
    v_exp_f32 v70, v70
    v_exp_f32 v71, v71
    v_smfmac_f32_32x32x32_bf16 v[176:191], a[8:11], v[112:119], v15
    v_exp_f32 v72, v72
    v_exp_f32 v73, v73
    v_exp_f32 v74, v74
    v_exp_f32 v75, v75
    v_smfmac_f32_32x32x32_bf16 v[176:191], a[12:15], v[120:127], v15
    s_waitcnt lgkmcnt(0)
    v_exp_f32 v76, v76
    v_exp_f32 v77, v77
    v_exp_f32 v78, v78
    v_exp_f32 v79, v79
    v_mfma_f32_32x32x16_bf16 v[96:111], a[0:3], v[32:35], 0
    ds_read_b128 a[8:11], v14 offset:22528
    v_exp_f32 v80, v80
    v_exp_f32 v81, v81
    v_exp_f32 v82, v82
    v_exp_f32 v83, v83
    v_mfma_f32_32x32x16_bf16 v[96:111], a[4:7], v[36:39], v[96:111]
L_pad3:
    s_cbranch_execz L_padret3
    ds_read_b128 a[12:15], v14 offset:23552
    v_exp_f32 v84, v84
    v_exp_f32 v85, v85
    v_exp_f32 v86, v86
    v_exp_f32 v87, v87
    v_smfmac_f32_32x32x32_bf16 v[160:175], a[56:59], v[64:71], v15
    v_exp_f32 v88, v88
    v_exp_f32 v89, v89
    v_exp_f32 v90, v90
    v_exp_f32 v91, v91
    v_smfmac_f32_32x32x32_bf16 v[160:175], a[60:63], v[72:79], v15
    ds_read_b128 a[48:51], v14 offset:24576
    ds_read_b128 a[52:55], v14 offset:25600
    v_exp_f32 v92, v92
    v_exp_f32 v93, v93
    v_exp_f32 v94, v94
    v_exp_f32 v95, v95
    v_mfma_f32_32x32x16_bf16 v[112:127], a[0:3], v[40:43], 0
    v_exp_f32 v96, v96
    v_exp_f32 v97, v97
    v_exp_f32 v98, v98
    v_exp_f32 v99, v99
    v_mfma_f32_32x32x16_bf16 v[112:127], a[4:7], v[44:47], v[112:127]
    v_exp_f32 v100, v100
    v_exp_f32 v101, v101
    v_exp_f32 v102, v102
    v_exp_f32 v103, v103
    v_smfmac_f32_32x32x32_bf16 v[176:191], a[56:59], v[80:87], v15
    v_exp_f32 v104, v104
    v_exp_f32 v105, v105
    v_exp_f32 v106, v106
    v_exp_f32 v107, v107
    v_smfmac_f32_32x32x32_bf16 v[176:191], a[60:63], v[88:95], v15
    s_waitcnt lgkmcnt(0)
    v_exp_f32 v108, v108
    v_exp_f32 v109, v109
    v_exp_f32 v110, v110
    v_exp_f32 v111, v111
    v_mfma_f32_32x32x16_bf16 v[64:79], a[48:51], v[32:35], 0
    ds_read_b128 a[56:59], v14 offset:26624
    v_exp_f32 v112, v112
    v_exp_f32 v113, v113
    v_exp_f32 v114, v114
    v_exp_f32 v115, v115
    v_mfma_f32_32x32x16_bf16 v[64:79], a[52:55], v[36:39], v[64:79]
    ds_read_b128 a[60:63], v14 offset:27648
    v_exp_f32 v116, v116
    v_exp_f32 v117, v117
    v_exp_f32 v118, v118
    v_exp_f32 v119, v119
    v_smfmac_f32_32x32x32_bf16 v[160:175], a[8:11], v[96:103], v15
    v_exp_f32 v120, v120
    v_exp_f32 v121, v121
    v_exp_f32 v122, v122
    v_exp_f32 v123, v123
    v_smfmac_f32_32x32x32_bf16 v[160:175], a[12:15], v[104:111], v15
    ds_read_b128 a[0:3], v14 offset:28672
    ds_read_b128 a[4:7], v14 offset:29696
    v_exp_f32 v124, v124
    v_exp_f32 v125, v125
    v_exp_f32 v126, v126
    v_exp_f32 v127, v127
    v_mfma_f32_32x32x16_bf16 v[80:95], a[48:51], v[40:43], 0
    v_exp_f32 v64, v64
    v_exp_f32 v65, v65
    v_exp_f32 v66, v66
    v_exp_f32 v67, v67
    v_mfma_f32_32x32x16_bf16 v[80:95], a[52:55], v[44:47], v[80:95]
    v_exp_f32 v68, v68
    v_exp_f32 v69, v69
    v_exp_f32 v70, v70
    v_exp_f32 v71, v71
    v_smfmac_f32_32x32x32_bf16 v[176:191], a[8:11], v[112:119], v15
    v_exp_f32 v72, v72
    v_exp_f32 v73, v73
    v_exp_f32 v74, v74
    v_exp_f32 v75, v75
    v_smfmac_f32_32x32x32_bf16 v[176:191], a[12:15], v[120:127], v15
    s_waitcnt lgkmcnt(0)
    v_exp_f32 v76, v76
    v_exp_f32 v77, v77
    v_exp_f32 v78, v78
    v_exp_f32 v79, v79
    v_mfma_f32_32x32x16_bf16 v[96:111], a[0:3], v[32:35], 0
    ds_read_b128 a[8:11], v14 offset:30720
    v_exp_f32 v80, v80
    v_exp_f32 v81, v81
    v_exp_f32 v82, v82
    v_exp_f32 v83, v83
    v_mfma_f32_32x32x16_bf16 v[96:111], a[4:7], v[36:39], v[96:111]
    ds_read_b128 a[12:15], v14 offset:31744
    v_exp_f32 v84, v84
    v_exp_f32 v85, v85
    v_exp_f32 v86, v86
    v_exp_f32 v87, v87
    v_smfmac_f32_32x32x32_bf16 v[160:175], a[56:59], v[64:71], v15
    s_waitcnt lgkmcnt(0)
    s_barrier
    v_exp_f32 v88, v88
    v_exp_f32 v89, v89
    v_exp_f32 v90, v90
    v_exp_f32 v91, v91
    v_smfmac_f32_32x32x32_bf16 v[160:175], a[60:63], v[72:79], v15
    ds_read_b128 a[48:51], v2 offset:0
    ds_read_b128 a[52:55], v2 offset:1024
    v_exp_f32 v92, v92
    v_exp_f32 v93, v93
    v_exp_f32 v94, v94
    v_exp_f32 v95, v95
    v_mfma_f32_32x32x16_bf16 v[112:127], a[0:3], v[40:43], 0
    v_exp_f32 v96, v96
    v_exp_f32 v97, v97
    v_exp_f32 v98, v98
    v_exp_f32 v99, v99
    v_mfma_f32_32x32x16_bf16 v[112:127], a[4:7], v[44:47], v[112:127]
    v_exp_f32 v100, v100
    v_exp_f32 v101, v101
    v_exp_f32 v102, v102
    v_exp_f32 v103, v103
    v_smfmac_f32_32x32x32_bf16 v[176:191], a[56:59], v[80:87], v15
    v_exp_f32 v104, v104
    v_exp_f32 v105, v105
    v_exp_f32 v106, v106
    v_exp_f32 v107, v107
    v_smfmac_f32_32x32x32_bf16 v[176:191], a[60:63], v[88:95], v15
    s_waitcnt lgkmcnt(0)
    v_exp_f32 v108, v108
    v_exp_f32 v109, v109
    v_exp_f32 v110, v110
    v_exp_f32 v111, v111
    v_mfma_f32_32x32x16_bf16 v[64:79], a[48:51], v[32:35], 0
    ds_read_b128 a[56:59], v2 offset:2048
    v_exp_f32 v112, v112
    v_exp_f32 v113, v113
    v_exp_f32 v114, v114
    v_exp_f32 v115, v115
    v_mfma_f32_32x32x16_bf16 v[64:79], a[52:55], v[36:39], v[64:79]
    ds_read_b128 a[60:63], v2 offset:3072
    v_exp_f32 v116, v116
    v_exp_f32 v117, v117
    v_exp_f32 v118, v118
    v_exp_f32 v119, v119
    v_smfmac_f32_32x32x32_bf16 v[160:175], a[8:11], v[96:103], v15
    v_exp_f32 v120, v120
    v_exp_f32 v121, v121
    v_exp_f32 v122, v122
    v_exp_f32 v123, v123
    v_smfmac_f32_32x32x32_bf16 v[160:175], a[12:15], v[104:111], v15
    ds_read_b128 a[0:3], v2 offset:4096
    ds_read_b128 a[4:7], v2 offset:5120
    v_exp_f32 v124, v124
    v_exp_f32 v125, v125
    v_exp_f32 v126, v126
    v_exp_f32 v127, v127
    v_mfma_f32_32x32x16_bf16 v[80:95], a[48:51], v[40:43], 0
    v_exp_f32 v64, v64
    v_exp_f32 v65, v65
    v_exp_f32 v66, v66
    v_exp_f32 v67, v67
    v_mfma_f32_32x32x16_bf16 v[80:95], a[52:55], v[44:47], v[80:95]
    v_exp_f32 v68, v68
    v_exp_f32 v69, v69
    v_exp_f32 v70, v70
    v_exp_f32 v71, v71
    v_smfmac_f32_32x32x32_bf16 v[176:191], a[8:11], v[112:119], v15
    v_exp_f32 v72, v72
    v_exp_f32 v73, v73
    v_exp_f32 v74, v74
    v_exp_f32 v75, v75
    v_smfmac_f32_32x32x32_bf16 v[176:191], a[12:15], v[120:127], v15
    s_waitcnt lgkmcnt(0)
    v_exp_f32 v76, v76
    v_exp_f32 v77, v77
    v_exp_f32 v78, v78
    v_exp_f32 v79, v79
    v_mfma_f32_32x32x16_bf16 v[96:111], a[0:3], v[32:35], 0
    ds_read_b128 a[8:11], v2 offset:6144
    v_exp_f32 v80, v80
    v_exp_f32 v81, v81
    v_exp_f32 v82, v82
    v_exp_f32 v83, v83
    v_mfma_f32_32x32x16_bf16 v[96:111], a[4:7], v[36:39], v[96:111]
    ds_read_b128 a[12:15], v2 offset:7168
    v_exp_f32 v84, v84
    v_exp_f32 v85, v85
    v_exp_f32 v86, v86
    v_exp_f32 v87, v87
    v_smfmac_f32_32x32x32_bf16 v[160:175], a[56:59], v[64:71], v15
    v_exp_f32 v88, v88
    v_exp_f32 v89, v89
    v_exp_f32 v90, v90
    v_exp_f32 v91, v91
    v_smfmac_f32_32x32x32_bf16 v[160:175], a[60:63], v[72:79], v15
    ds_read_b128 a[48:51], v2 offset:8192
    ds_read_b128 a[52:55], v2 offset:9216
    v_exp_f32 v92, v92
    v_exp_f32 v93, v93
    v_exp_f32 v94, v94
    v_exp_f32 v95, v95
    v_mfma_f32_32x32x16_bf16 v[112:127], a[0:3], v[40:43], 0
    v_exp_f32 v96, v96
    v_exp_f32 v97, v97
    v_exp_f32 v98, v98
    v_exp_f32 v99, v99
    v_mfma_f32_32x32x16_bf16 v[112:127], a[4:7], v[44:47], v[112:127]
    v_exp_f32 v100, v100
    v_exp_f32 v101, v101
    v_exp_f32 v102, v102
    v_exp_f32 v103, v103
    v_smfmac_f32_32x32x32_bf16 v[176:191], a[56:59], v[80:87], v15
    v_exp_f32 v104, v104
    v_exp_f32 v105, v105
    v_exp_f32 v106, v106
    v_exp_f32 v107, v107
    v_smfmac_f32_32x32x32_bf16 v[176:191], a[60:63], v[88:95], v15
    s_waitcnt lgkmcnt(0)
    v_exp_f32 v108, v108
    v_exp_f32 v109, v109
    v_exp_f32 v110, v110
    v_exp_f32 v111, v111
    v_mfma_f32_32x32x16_bf16 v[64:79], a[48:51], v[32:35], 0
    ds_read_b128 a[56:59], v2 offset:10240
    v_exp_f32 v112, v112
    v_exp_f32 v113, v113
    v_exp_f32 v114, v114
    v_exp_f32 v115, v115
    v_mfma_f32_32x32x16_bf16 v[64:79], a[52:55], v[36:39], v[64:79]
    ds_read_b128 a[60:63], v2 offset:11264
    v_exp_f32 v116, v116
    v_exp_f32 v117, v117
    v_exp_f32 v118, v118
    v_exp_f32 v119, v119
    v_smfmac_f32_32x32x32_bf16 v[160:175], a[8:11], v[96:103], v15
    v_exp_f32 v120, v120
    v_exp_f32 v121, v121
    v_exp_f32 v122, v122
    v_exp_f32 v123, v123
    v_smfmac_f32_32x32x32_bf16 v[160:175], a[12:15], v[104:111], v15
    ds_read_b128 a[0:3], v2 offset:12288
    ds_read_b128 a[4:7], v2 offset:13312
    v_exp_f32 v124, v124
    v_exp_f32 v125, v125
    v_exp_f32 v126, v126
    v_exp_f32 v127, v127
    v_mfma_f32_32x32x16_bf16 v[80:95], a[48:51], v[40:43], 0
    v_exp_f32 v64, v64
    v_exp_f32 v65, v65
    v_exp_f32 v66, v66
    v_exp_f32 v67, v67
    v_mfma_f32_32x32x16_bf16 v[80:95], a[52:55], v[44:47], v[80:95]
    v_exp_f32 v68, v68
    v_exp_f32 v69, v69
    v_exp_f32 v70, v70
    v_exp_f32 v71, v71
    v_smfmac_f32_32x32x32_bf16 v[176:191], a[8:11], v[112:119], v15
    v_exp_f32 v72, v72
    v_exp_f32 v73, v73
    v_exp_f32 v74, v74
    v_exp_f32 v75, v75
    v_smfmac_f32_32x32x32_bf16 v[176:191], a[12:15], v[120:127], v15
    s_waitcnt lgkmcnt(0)
    v_exp_f32 v76, v76
    v_exp_f32 v77, v77
    v_exp_f32 v78, v78
    v_exp_f32 v79, v79
    v_mfma_f32_32x32x16_bf16 v[96:111], a[0:3], v[32:35], 0
    ds_read_b128 a[8:11], v2 offset:14336
    v_exp_f32 v80, v80
    v_exp_f32 v81, v81
    v_exp_f32 v82, v82
    v_exp_f32 v83, v83
    v_mfma_f32_32x32x16_bf16 v[96:111], a[4:7], v[36:39], v[96:111]
    ds_read_b128 a[12:15], v2 offset:15360
    v_exp_f32 v84, v84
    v_exp_f32 v85, v85
    v_exp_f32 v86, v86
    v_exp_f32 v87, v87
    v_smfmac_f32_32x32x32_bf16 v[160:175], a[56:59], v[64:71], v15
    v_exp_f32 v88, v88
    v_exp_f32 v89, v89
    v_exp_f32 v90, v90
    v_exp_f32 v91, v91
    v_smfmac_f32_32x32x32_bf16 v[160:175], a[60:63], v[72:79], v15
    ds_read_b128 a[48:51], v2 offset:16384
    ds_read_b128 a[52:55], v2 offset:17408
    v_exp_f32 v92, v92
    v_exp_f32 v93, v93
    v_exp_f32 v94, v94
    v_exp_f32 v95, v95
    v_mfma_f32_32x32x16_bf16 v[112:127], a[0:3], v[40:43], 0
    v_exp_f32 v96, v96
    v_exp_f32 v97, v97
    v_exp_f32 v98, v98
    v_exp_f32 v99, v99
    v_mfma_f32_32x32x16_bf16 v[112:127], a[4:7], v[44:47], v[112:127]
    v_exp_f32 v100, v100
    v_exp_f32 v101, v101
    v_exp_f32 v102, v102
    v_exp_f32 v103, v103
    v_smfmac_f32_32x32x32_bf16 v[176:191], a[56:59], v[80:87], v15
    v_exp_f32 v104, v104
    v_exp_f32 v105, v105
    v_exp_f32 v106, v106
    v_exp_f32 v107, v107
    v_smfmac_f32_32x32x32_bf16 v[176:191], a[60:63], v[88:95], v15
    s_waitcnt lgkmcnt(0)
    v_exp_f32 v108, v108
    v_exp_f32 v109, v109
    v_exp_f32 v110, v110
    v_exp_f32 v111, v111
    v_mfma_f32_32x32x16_bf16 v[64:79], a[48:51], v[32:35], 0
    ds_read_b128 a[56:59], v2 offset:18432
    v_exp_f32 v112, v112
    v_exp_f32 v113, v113
    v_exp_f32 v114, v114
    v_exp_f32 v115, v115
    v_mfma_f32_32x32x16_bf16 v[64:79], a[52:55], v[36:39], v[64:79]
    ds_read_b128 a[60:63], v2 offset:19456
    v_exp_f32 v116, v116
    v_exp_f32 v117, v117
    v_exp_f32 v118, v118
    v_exp_f32 v119, v119
    v_smfmac_f32_32x32x32_bf16 v[160:175], a[8:11], v[96:103], v15
    v_exp_f32 v120, v120
    v_exp_f32 v121, v121
    v_exp_f32 v122, v122
    v_exp_f32 v123, v123
    v_smfmac_f32_32x32x32_bf16 v[160:175], a[12:15], v[104:111], v15
    ds_read_b128 a[0:3], v2 offset:20480
    ds_read_b128 a[4:7], v2 offset:21504
    v_exp_f32 v124, v124
    v_exp_f32 v125, v125
    v_exp_f32 v126, v126
    v_exp_f32 v127, v127
    v_mfma_f32_32x32x16_bf16 v[80:95], a[48:51], v[40:43], 0
    v_exp_f32 v64, v64
    v_exp_f32 v65, v65
    v_exp_f32 v66, v66
    v_exp_f32 v67, v67
    v_mfma_f32_32x32x16_bf16 v[80:95], a[52:55], v[44:47], v[80:95]
    v_exp_f32 v68, v68
    v_exp_f32 v69, v69
    v_exp_f32 v70, v70
    v_exp_f32 v71, v71
    v_smfmac_f32_32x32x32_bf16 v[176:191], a[8:11], v[112:119], v15
    v_exp_f32 v72, v72
    v_exp_f32 v73, v73
    v_exp_f32 v74, v74
    v_exp_f32 v75, v75
    v_smfmac_f32_32x32x32_bf16 v[176:191], a[12:15], v[120:127], v15
    s_waitcnt lgkmcnt(0)
    v_exp_f32 v76, v76
    v_exp_f32 v77, v77
    v_exp_f32 v78, v78
    v_exp_f32 v79, v79
    v_mfma_f32_32x32x16_bf16 v[96:111], a[0:3], v[32:35], 0
    ds_read_b128 a[8:11], v2 offset:22528
    v_exp_f32 v80, v80
    v_exp_f32 v81, v81
    v_exp_f32 v82, v82
    v_exp_f32 v83, v83
    v_mfma_f32_32x32x16_bf16 v[96:111], a[4:7], v[36:39], v[96:111]
    ds_read_b128 a[12:15], v2 offset:23552
    v_exp_f32 v84, v84
    v_exp_f32 v85, v85
    v_exp_f32 v86, v86
    v_exp_f32 v87, v87
    v_smfmac_f32_32x32x32_bf16 v[160:175], a[56:59], v[64:71], v15
    v_exp_f32 v88, v88
    v_exp_f32 v89, v89
    v_exp_f32 v90, v90
    v_exp_f32 v91, v91
    v_smfmac_f32_32x32x32_bf16 v[160:175], a[60:63], v[72:79], v15
    ds_read_b128 a[48:51], v2 offset:24576
    ds_read_b128 a[52:55], v2 offset:25600
    v_exp_f32 v92, v92
    v_exp_f32 v93, v93
    v_exp_f32 v94, v94
    v_exp_f32 v95, v95
    v_mfma_f32_32x32x16_bf16 v[112:127], a[0:3], v[40:43], 0
    v_exp_f32 v96, v96
    v_exp_f32 v97, v97
    v_exp_f32 v98, v98
    v_exp_f32 v99, v99
    v_mfma_f32_32x32x16_bf16 v[112:127], a[4:7], v[44:47], v[112:127]
    v_exp_f32 v100, v100
    v_exp_f32 v101, v101
    v_exp_f32 v102, v102
    v_exp_f32 v103, v103
    v_smfmac_f32_32x32x32_bf16 v[176:191], a[56:59], v[80:87], v15
    v_exp_f32 v104, v104
    v_exp_f32 v105, v105
    v_exp_f32 v106, v106
    v_exp_f32 v107, v107
    v_smfmac_f32_32x32x32_bf16 v[176:191], a[60:63], v[88:95], v15
    s_waitcnt lgkmcnt(0)
    v_exp_f32 v108, v108
    v_exp_f32 v109, v109
    v_exp_f32 v110, v110
    v_exp_f32 v111, v111
    v_mfma_f32_32x32x16_bf16 v[64:79], a[48:51], v[32:35], 0
    ds_read_b128 a[56:59], v2 offset:26624
    v_exp_f32 v112, v112
    v_exp_f32 v113, v113
    v_exp_f32 v114, v114
    v_exp_f32 v115, v115
    v_mfma_f32_32x32x16_bf16 v[64:79], a[52:55], v[36:39], v[64:79]
    ds_read_b128 a[60:63], v2 offset:27648
    v_exp_f32 v116, v116
    v_exp_f32 v117, v117
    v_exp_f32 v118, v118
    v_exp_f32 v119, v119
    v_smfmac_f32_32x32x32_bf16 v[160:175], a[8:11], v[96:103], v15
    v_exp_f32 v120, v120
    v_exp_f32 v121, v121
    v_exp_f32 v122, v122
    v_exp_f32 v123, v123
    v_smfmac_f32_32x32x32_bf16 v[160:175], a[12:15], v[104:111], v15
    ds_read_b128 a[0:3], v2 offset:28672
    ds_read_b128 a[4:7], v2 offset:29696
    v_exp_f32 v124, v124
    v_exp_f32 v125, v125
    v_exp_f32 v126, v126
    v_exp_f32 v127, v127
    v_mfma_f32_32x32x16_bf16 v[80:95], a[48:51], v[40:43], 0
    v_exp_f32 v64, v64
    v_exp_f32 v65, v65
    v_exp_f32 v66, v66
    v_exp_f32 v67, v67
    v_mfma_f32_32x32x16_bf16 v[80:95], a[52:55], v[44:47], v[80:95]
    v_exp_f32 v68, v68
    v_exp_f32 v69, v69
    v_exp_f32 v70, v70
    v_exp_f32 v71, v71
    v_smfmac_f32_32x32x32_bf16 v[176:191], a[8:11], v[112:119], v15
    v_exp_f32 v72, v72
    v_exp_f32 v73, v73
    v_exp_f32 v74, v74
    v_exp_f32 v75, v75
    v_smfmac_f32_32x32x32_bf16 v[176:191], a[12:15], v[120:127], v15
    s_waitcnt lgkmcnt(0)
    v_exp_f32 v76, v76
    v_exp_f32 v77, v77
    v_exp_f32 v78, v78
    v_exp_f32 v79, v79
    v_mfma_f32_32x32x16_bf16 v[96:111], a[0:3], v[32:35], 0
    ds_read_b128 a[8:11], v2 offset:30720
    v_exp_f32 v80, v80
    v_exp_f32 v81, v81
    v_exp_f32 v82, v82
    v_exp_f32 v83, v83
    v_mfma_f32_32x32x16_bf16 v[96:111], a[4:7], v[36:39], v[96:111]
    ds_read_b128 a[12:15], v2 offset:31744
    v_exp_f32 v84, v84
    v_exp_f32 v85, v85
    v_exp_f32 v86, v86
    v_exp_f32 v87, v87
    v_smfmac_f32_32x32x32_bf16 v[160:175], a[56:59], v[64:71], v15
    s_waitcnt lgkmcnt(0)
    s_barrier
    v_exp_f32 v88, v88
    v_exp_f32 v89, v89
    v_exp_f32 v90, v90
    v_exp_f32 v91, v91
    v_smfmac_f32_32x32x32_bf16 v[160:175], a[60:63], v[72:79], v15
    ds_read_b128 a[48:51], v2 offset:32768
    ds_read_b128 a[52:55], v2 offset:33792
    v_exp_f32 v92, v92
    v_exp_f32 v93, v93
    v_exp_f32 v94, v94
    v_exp_f32 v95, v95
    v_mfma_f32_32x32x16_bf16 v[112:127], a[0:3], v[40:43], 0
    v_exp_f32 v96, v96
    v_exp_f32 v97, v97
    v_exp_f32 v98, v98
    v_exp_f32 v99, v99
    v_mfma_f32_32x32x16_bf16 v[112:127], a[4:7], v[44:47], v[112:127]
    v_exp_f32 v100, v100
    v_exp_f32 v101, v101
    v_exp_f32 v102, v102
    v_exp_f32 v103, v103
    v_smfmac_f32_32x32x32_bf16 v[176:191], a[56:59], v[80:87], v15
    v_exp_f32 v104, v104
    v_exp_f32 v105, v105
    v_exp_f32 v106, v106
    v_exp_f32 v107, v107
    v_smfmac_f32_32x32x32_bf16 v[176:191], a[60:63], v[88:95], v15
    s_waitcnt lgkmcnt(0)
    v_exp_f32 v108, v108
    v_exp_f32 v109, v109
    v_exp_f32 v110, v110
    v_exp_f32 v111, v111
    v_mfma_f32_32x32x16_bf16 v[64:79], a[48:51], v[32:35], 0
    ds_read_b128 a[56:59], v2 offset:34816
    v_exp_f32 v112, v112
    v_exp_f32 v113, v113
    v_exp_f32 v114, v114
    v_exp_f32 v115, v115
    v_mfma_f32_32x32x16_bf16 v[64:79], a[52:55], v[36:39], v[64:79]
    ds_read_b128 a[60:63], v2 offset:35840
    v_exp_f32 v116, v116
    v_exp_f32 v117, v117
    v_exp_f32 v118, v118
    v_exp_f32 v119, v119
    v_smfmac_f32_32x32x32_bf16 v[160:175], a[8:11], v[96:103], v15
    v_exp_f32 v120, v120
    v_exp_f32 v121, v121
    v_exp_f32 v122, v122
    v_exp_f32 v123, v123
    v_smfmac_f32_32x32x32_bf16 v[160:175], a[12:15], v[104:111], v15
    ds_read_b128 a[0:3], v2 offset:36864
    ds_read_b128 a[4:7], v2 offset:37888
    v_exp_f32 v124, v124
    v_exp_f32 v125, v125
    v_exp_f32 v126, v126
    v_exp_f32 v127, v127
    v_mfma_f32_32x32x16_bf16 v[80:95], a[48:51], v[40:43], 0
    v_exp_f32 v64, v64
    v_exp_f32 v65, v65
    v_exp_f32 v66, v66
    v_exp_f32 v67, v67
    v_mfma_f32_32x32x16_bf16 v[80:95], a[52:55], v[44:47], v[80:95]
    v_exp_f32 v68, v68
    v_exp_f32 v69, v69
    v_exp_f32 v70, v70
    v_exp_f32 v71, v71
    v_smfmac_f32_32x32x32_bf16 v[176:191], a[8:11], v[112:119], v15
    v_exp_f32 v72, v72
    v_exp_f32 v73, v73
    v_exp_f32 v74, v74
    v_exp_f32 v75, v75
    v_smfmac_f32_32x32x32_bf16 v[176:191], a[12:15], v[120:127], v15
    s_waitcnt lgkmcnt(0)
    v_exp_f32 v76, v76
    v_exp_f32 v77, v77
    v_exp_f32 v78, v78
    v_exp_f32 v79, v79
    v_mfma_f32_32x32x16_bf16 v[96:111], a[0:3], v[32:35], 0
    ds_read_b128 a[8:11], v2 offset:38912
    v_exp_f32 v80, v80
    v_exp_f32 v81, v81
    v_exp_f32 v82, v82
    v_exp_f32 v83, v83
    v_mfma_f32_32x32x16_bf16 v[96:111], a[4:7], v[36:39], v[96:111]
    ds_read_b128 a[12:15], v2 offset:39936
    v_exp_f32 v84, v84
    v_exp_f32 v85, v85
    v_exp_f32 v86, v86
    v_exp_f32 v87, v87
    v_smfmac_f32_32x32x32_bf16 v[160:175], a[56:59], v[64:71], v15
    v_exp_f32 v88, v88
    v_exp_f32 v89, v89
    v_exp_f32 v90, v90
    v_exp_f32 v91, v91
    v_smfmac_f32_32x32x32_bf16 v[160:175], a[60:63], v[72:79], v15
    ds_read_b128 a[48:51], v2 offset:40960
    ds_read_b128 a[52:55], v2 offset:41984
    v_exp_f32 v92, v92
    v_exp_f32 v93, v93
    v_exp_f32 v94, v94
    v_exp_f32 v95, v95
    v_mfma_f32_32x32x16_bf16 v[112:127], a[0:3], v[40:43], 0
    v_exp_f32 v96, v96
    v_exp_f32 v97, v97
    v_exp_f32 v98, v98
    v_exp_f32 v99, v99
    v_mfma_f32_32x32x16_bf16 v[112:127], a[4:7], v[44:47], v[112:127]
    v_exp_f32 v100, v100
    v_exp_f32 v101, v101
    v_exp_f32 v102, v102
    v_exp_f32 v103, v103
    v_smfmac_f32_32x32x32_bf16 v[176:191], a[56:59], v[80:87], v15
    v_exp_f32 v104, v104
    v_exp_f32 v105, v105
    v_exp_f32 v106, v106
    v_exp_f32 v107, v107
    v_smfmac_f32_32x32x32_bf16 v[176:191], a[60:63], v[88:95], v15
    s_waitcnt lgkmcnt(0)
    v_exp_f32 v108, v108
    v_exp_f32 v109, v109
    v_exp_f32 v110, v110
    v_exp_f32 v111, v111
    v_mfma_f32_32x32x16_bf16 v[64:79], a[48:51], v[32:35], 0
    ds_read_b128 a[56:59], v2 offset:43008
    v_exp_f32 v112, v112
    v_exp_f32 v113, v113
    v_exp_f32 v114, v114
    v_exp_f32 v115, v115
    v_mfma_f32_32x32x16_bf16 v[64:79], a[52:55], v[36:39], v[64:79]
    ds_read_b128 a[60:63], v2 offset:44032
    v_exp_f32 v116, v116
    v_exp_f32 v117, v117
    v_exp_f32 v118, v118
    v_exp_f32 v119, v119
    v_smfmac_f32_32x32x32_bf16 v[160:175], a[8:11], v[96:103], v15
    v_exp_f32 v120, v120
    v_exp_f32 v121, v121
    v_exp_f32 v122, v122
    v_exp_f32 v123, v123
    v_smfmac_f32_32x32x32_bf16 v[160:175], a[12:15], v[104:111], v15
    ds_read_b128 a[0:3], v2 offset:45056
    ds_read_b128 a[4:7], v2 offset:46080
    v_exp_f32 v124, v124
    v_exp_f32 v125, v125
    v_exp_f32 v126, v126
    v_exp_f32 v127, v127
    v_mfma_f32_32x32x16_bf16 v[80:95], a[48:51], v[40:43], 0
    v_exp_f32 v64, v64
    v_exp_f32 v65, v65
    v_exp_f32 v66, v66
    v_exp_f32 v67, v67
    v_mfma_f32_32x32x16_bf16 v[80:95], a[52:55], v[44:47], v[80:95]
    v_exp_f32 v68, v68
    v_exp_f32 v69, v69
    v_exp_f32 v70, v70
    v_exp_f32 v71, v71
    v_smfmac_f32_32x32x32_bf16 v[176:191], a[8:11], v[112:119], v15
    v_exp_f32 v72, v72
    v_exp_f32 v73, v73
    v_exp_f32 v74, v74
    v_exp_f32 v75, v75
    v_smfmac_f32_32x32x32_bf16 v[176:191], a[12:15], v[120:127], v15
    s_waitcnt lgkmcnt(0)
    v_exp_f32 v76, v76
    v_exp_f32 v77, v77
    v_exp_f32 v78, v78
    v_exp_f32 v79, v79
    v_mfma_f32_32x32x16_bf16 v[96:111], a[0:3], v[32:35], 0
    ds_read_b128 a[8:11], v2 offset:47104
    v_exp_f32 v80, v80
    v_exp_f32 v81, v81
    v_exp_f32 v82, v82
    v_exp_f32 v83, v83
    v_mfma_f32_32x32x16_bf16 v[96:111], a[4:7], v[36:39], v[96:111]
    ds_read_b128 a[12:15], v2 offset:48128
    v_exp_f32 v84, v84
    v_exp_f32 v85, v85
    v_exp_f32 v86, v86
    v_exp_f32 v87, v87
    v_smfmac_f32_32x32x32_bf16 v[160:175], a[56:59], v[64:71], v15
    v_exp_f32 v88, v88
    v_exp_f32 v89, v89
    v_exp_f32 v90, v90
    v_exp_f32 v91, v91
    v_smfmac_f32_32x32x32_bf16 v[160:175], a[60:63], v[72:79], v15
    ds_read_b128 a[48:51], v2 offset:49152
    ds_read_b128 a[52:55], v2 offset:50176
    v_exp_f32 v92, v92
    v_exp_f32 v93, v93
    v_exp_f32 v94, v94
    v_exp_f32 v95, v95
    v_mfma_f32_32x32x16_bf16 v[112:127], a[0:3], v[40:43], 0
    v_exp_f32 v96, v96
    v_exp_f32 v97, v97
    v_exp_f32 v98, v98
    v_exp_f32 v99, v99
    v_mfma_f32_32x32x16_bf16 v[112:127], a[4:7], v[44:47], v[112:127]
    v_exp_f32 v100, v100
    v_exp_f32 v101, v101
    v_exp_f32 v102, v102
    v_exp_f32 v103, v103
    v_smfmac_f32_32x32x32_bf16 v[176:191], a[56:59], v[80:87], v15
    v_exp_f32 v104, v104
    v_exp_f32 v105, v105
    v_exp_f32 v106, v106
    v_exp_f32 v107, v107
    v_smfmac_f32_32x32x32_bf16 v[176:191], a[60:63], v[88:95], v15
    s_waitcnt lgkmcnt(0)
    v_exp_f32 v108, v108
    v_exp_f32 v109, v109
    v_exp_f32 v110, v110
    v_exp_f32 v111, v111
    v_mfma_f32_32x32x16_bf16 v[64:79], a[48:51], v[32:35], 0
    ds_read_b128 a[56:59], v2 offset:51200
    v_exp_f32 v112, v112
    v_exp_f32 v113, v113
    v_exp_f32 v114, v114
    v_exp_f32 v115, v115
    v_mfma_f32_32x32x16_bf16 v[64:79], a[52:55], v[36:39], v[64:79]
    ds_read_b128 a[60:63], v2 offset:52224
    v_exp_f32 v116, v116
    v_exp_f32 v117, v117
    v_exp_f32 v118, v118
    v_exp_f32 v119, v119
    v_smfmac_f32_32x32x32_bf16 v[160:175], a[8:11], v[96:103], v15
    v_exp_f32 v120, v120
    v_exp_f32 v121, v121
    v_exp_f32 v122, v122
    v_exp_f32 v123, v123
    v_smfmac_f32_32x32x32_bf16 v[160:175], a[12:15], v[104:111], v15
    ds_read_b128 a[0:3], v2 offset:53248
    ds_read_b128 a[4:7], v2 offset:54272
    v_exp_f32 v124, v124
    v_exp_f32 v125, v125
    v_exp_f32 v126, v126
    v_exp_f32 v127, v127
    v_mfma_f32_32x32x16_bf16 v[80:95], a[48:51], v[40:43], 0
    v_exp_f32 v64, v64
    v_exp_f32 v65, v65
    v_exp_f32 v66, v66
    v_exp_f32 v67, v67
    v_mfma_f32_32x32x16_bf16 v[80:95], a[52:55], v[44:47], v[80:95]
    v_exp_f32 v68, v68
    v_exp_f32 v69, v69
    v_exp_f32 v70, v70
    v_exp_f32 v71, v71
    v_smfmac_f32_32x32x32_bf16 v[176:191], a[8:11], v[112:119], v15
    v_exp_f32 v72, v72
    v_exp_f32 v73, v73
    v_exp_f32 v74, v74
    v_exp_f32 v75, v75
    v_smfmac_f32_32x32x32_bf16 v[176:191], a[12:15], v[120:127], v15
    s_waitcnt lgkmcnt(0)
    v_exp_f32 v76, v76
    v_exp_f32 v77, v77
    v_exp_f32 v78, v78
    v_exp_f32 v79, v79
    v_mfma_f32_32x32x16_bf16 v[96:111], a[0:3], v[32:35], 0
    ds_read_b128 a[8:11], v2 offset:55296
    v_exp_f32 v80, v80
    v_exp_f32 v81, v81
    v_exp_f32 v82, v82
    v_exp_f32 v83, v83
    v_mfma_f32_32x32x16_bf16 v[96:111], a[4:7], v[36:39], v[96:111]
    ds_read_b128 a[12:15], v2 offset:56320
    v_exp_f32 v84, v84
    v_exp_f32 v85, v85
    v_exp_f32 v86, v86
    v_exp_f32 v87, v87
    v_smfmac_f32_32x32x32_bf16 v[160:175], a[56:59], v[64:71], v15
    v_exp_f32 v88, v88
    v_exp_f32 v89, v89
    v_exp_f32 v90, v90
    v_exp_f32 v91, v91
    v_smfmac_f32_32x32x32_bf16 v[160:175], a[60:63], v[72:79], v15
    ds_read_b128 a[48:51], v2 offset:57344
    ds_read_b128 a[52:55], v2 offset:58368
    v_exp_f32 v92, v92
    v_exp_f32 v93, v93
    v_exp_f32 v94, v94
    v_exp_f32 v95, v95
    v_mfma_f32_32x32x16_bf16 v[112:127], a[0:3], v[40:43], 0
    v_exp_f32 v96, v96
    v_exp_f32 v97, v97
    v_exp_f32 v98, v98
    v_exp_f32 v99, v99
    v_mfma_f32_32x32x16_bf16 v[112:127], a[4:7], v[44:47], v[112:127]
    v_exp_f32 v100, v100
    v_exp_f32 v101, v101
    v_exp_f32 v102, v102
    v_exp_f32 v103, v103
    v_smfmac_f32_32x32x32_bf16 v[176:191], a[56:59], v[80:87], v15
    v_exp_f32 v104, v104
    v_exp_f32 v105, v105
    v_exp_f32 v106, v106
    v_exp_f32 v107, v107
    v_smfmac_f32_32x32x32_bf16 v[176:191], a[60:63], v[88:95], v15
    s_waitcnt lgkmcnt(0)
    v_exp_f32 v108, v108
    v_exp_f32 v109, v109
    v_exp_f32 v110, v110
    v_exp_f32 v111, v111
    v_mfma_f32_32x32x16_bf16 v[64:79], a[48:51], v[32:35], 0
    ds_read_b128 a[56:59], v2 offset:59392
    v_exp_f32 v112, v112
    v_exp_f32 v113, v113
    v_exp_f32 v114, v114
    v_exp_f32 v115, v115
    v_mfma_f32_32x32x16_bf16 v[64:79], a[52:55], v[36:39], v[64:79]
    ds_read_b128 a[60:63], v2 offset:60416
    v_exp_f32 v116, v116
    v_exp_f32 v117, v117
    v_exp_f32 v118, v118
    v_exp_f32 v119, v119
    v_smfmac_f32_32x32x32_bf16 v[160:175], a[8:11], v[96:103], v15
    v_exp_f32 v120, v120
    v_exp_f32 v121, v121
    v_exp_f32 v122, v122
    v_exp_f32 v123, v123
    v_smfmac_f32_32x32x32_bf16 v[160:175], a[12:15], v[104:111], v15
    ds_read_b128 a[0:3], v2 offset:61440
    ds_read_b128 a[4:7], v2 offset:62464
    v_exp_f32 v124, v124
    v_exp_f32 v125, v125
    v_exp_f32 v126, v126
    v_exp_f32 v127, v127
    v_mfma_f32_32x32x16_bf16 v[80:95], a[48:51], v[40:43], 0
    v_exp_f32 v64, v64
    v_exp_f32 v65, v65
    v_exp_f32 v66, v66
    v_exp_f32 v67, v67
    v_mfma_f32_32x32x16_bf16 v[80:95], a[52:55], v[44:47], v[80:95]
    v_exp_f32 v68, v68
    v_exp_f32 v69, v69
    v_exp_f32 v70, v70
    v_exp_f32 v71, v71
    v_smfmac_f32_32x32x32_bf16 v[176:191], a[8:11], v[112:119], v15
    v_exp_f32 v72, v72
    v_exp_f32 v73, v73
    v_exp_f32 v74, v74
    v_exp_f32 v75, v75
    v_smfmac_f32_32x32x32_bf16 v[176:191], a[12:15], v[120:127], v15
    s_waitcnt lgkmcnt(0)
    v_exp_f32 v76, v76
    v_exp_f32 v77, v77
    v_exp_f32 v78, v78
    v_exp_f32 v79, v79
    v_mfma_f32_32x32x16_bf16 v[96:111], a[0:3], v[32:35], 0
L_pad4:
    s_cbranch_execz L_padret4
    ds_read_b128 a[8:11], v2 offset:63488
    v_exp_f32 v80, v80
    v_exp_f32 v81, v81
    v_exp_f32 v82, v82
    v_exp_f32 v83, v83
    v_mfma_f32_32x32x16_bf16 v[96:111], a[4:7], v[36:39], v[96:111]
    ds_read_b128 a[12:15], v2 offset:64512
    v_exp_f32 v84, v84
    v_exp_f32 v85, v85
    v_exp_f32 v86, v86
    v_exp_f32 v87, v87
    v_smfmac_f32_32x32x32_bf16 v[160:175], a[56:59], v[64:71], v15
    s_waitcnt lgkmcnt(0)
    s_barrier
    v_exp_f32 v88, v88
    v_exp_f32 v89, v89
    v_exp_f32 v90, v90
    v_exp_f32 v91, v91
    v_smfmac_f32_32x32x32_bf16 v[160:175], a[60:63], v[72:79], v15
    ds_read_b128 a[48:51], v14 offset:0
    ds_read_b128 a[52:55], v14 offset:1024
    v_exp_f32 v92, v92
    v_exp_f32 v93, v93
    v_exp_f32 v94, v94
    v_exp_f32 v95, v95
    v_mfma_f32_32x32x16_bf16 v[112:127], a[0:3], v[40:43], 0
    v_exp_f32 v96, v96
    v_exp_f32 v97, v97
    v_exp_f32 v98, v98
    v_exp_f32 v99, v99
    v_mfma_f32_32x32x16_bf16 v[112:127], a[4:7], v[44:47], v[112:127]
    v_exp_f32 v100, v100
    v_exp_f32 v101, v101
    v_exp_f32 v102, v102
    v_exp_f32 v103, v103
    v_smfmac_f32_32x32x32_bf16 v[176:191], a[56:59], v[80:87], v15
    v_exp_f32 v104, v104
    v_exp_f32 v105, v105
    v_exp_f32 v106, v106
    v_exp_f32 v107, v107
    v_smfmac_f32_32x32x32_bf16 v[176:191], a[60:63], v[88:95], v15
    s_waitcnt lgkmcnt(0)
    v_exp_f32 v108, v108
    v_exp_f32 v109, v109
    v_exp_f32 v110, v110
    v_exp_f32 v111, v111
    v_mfma_f32_32x32x16_bf16 v[64:79], a[48:51], v[32:35], 0
    ds_read_b128 a[56:59], v14 offset:2048
    v_exp_f32 v112, v112
    v_exp_f32 v113, v113
    v_exp_f32 v114, v114
    v_exp_f32 v115, v115
    v_mfma_f32_32x32x16_bf16 v[64:79], a[52:55], v[36:39], v[64:79]
    ds_read_b128 a[60:63], v14 offset:3072
    v_exp_f32 v116, v116
    v_exp_f32 v117, v117
    v_exp_f32 v118, v118
    v_exp_f32 v119, v119
    v_smfmac_f32_32x32x32_bf16 v[160:175], a[8:11], v[96:103], v15
    v_exp_f32 v120, v120
    v_exp_f32 v121, v121
    v_exp_f32 v122, v122
    v_exp_f32 v123, v123
    v_smfmac_f32_32x32x32_bf16 v[160:175], a[12:15], v[104:111], v15
    ds_read_b128 a[0:3], v14 offset:4096
    ds_read_b128 a[4:7], v14 offset:5120
    v_exp_f32 v124, v124
    v_exp_f32 v125, v125
    v_exp_f32 v126, v126
    v_exp_f32 v127, v127
    v_mfma_f32_32x32x16_bf16 v[80:95], a[48:51], v[40:43], 0
    v_exp_f32 v64, v64
    v_exp_f32 v65, v65
    v_exp_f32 v66, v66
    v_exp_f32 v67, v67
    v_mfma_f32_32x32x16_bf16 v[80:95], a[52:55], v[44:47], v[80:95]
    v_exp_f32 v68, v68
    v_exp_f32 v69, v69
    v_exp_f32 v70, v70
    v_exp_f32 v71, v71
    v_smfmac_f32_32x32x32_bf16 v[176:191], a[8:11], v[112:119], v15
    v_exp_f32 v72, v72
    v_exp_f32 v73, v73
    v_exp_f32 v74, v74
    v_exp_f32 v75, v75
    v_smfmac_f32_32x32x32_bf16 v[176:191], a[12:15], v[120:127], v15
    s_waitcnt lgkmcnt(0)
    v_exp_f32 v76, v76
    v_exp_f32 v77, v77
    v_exp_f32 v78, v78
    v_exp_f32 v79, v79
    v_mfma_f32_32x32x16_bf16 v[96:111], a[0:3], v[32:35], 0
    ds_read_b128 a[8:11], v14 offset:6144
    v_exp_f32 v80, v80
    v_exp_f32 v81, v81
    v_exp_f32 v82, v82
    v_exp_f32 v83, v83
    v_mfma_f32_32x32x16_bf16 v[96:111], a[4:7], v[36:39], v[96:111]
    ds_read_b128 a[12:15], v14 offset:7168
    v_exp_f32 v84, v84
    v_exp_f32 v85, v85
    v_exp_f32 v86, v86
    v_exp_f32 v87, v87
    v_smfmac_f32_32x32x32_bf16 v[160:175], a[56:59], v[64:71], v15
    v_exp_f32 v88, v88
    v_exp_f32 v89, v89
    v_exp_f32 v90, v90
    v_exp_f32 v91, v91
    v_smfmac_f32_32x32x32_bf16 v[160:175], a[60:63], v[72:79], v15
    ds_read_b128 a[48:51], v14 offset:8192
    ds_read_b128 a[52:55], v14 offset:9216
    v_exp_f32 v92, v92
    v_exp_f32 v93, v93
    v_exp_f32 v94, v94
    v_exp_f32 v95, v95
    v_mfma_f32_32x32x16_bf16 v[112:127], a[0:3], v[40:43], 0
    v_exp_f32 v96, v96
    v_exp_f32 v97, v97
    v_exp_f32 v98, v98
    v_exp_f32 v99, v99
    v_mfma_f32_32x32x16_bf16 v[112:127], a[4:7], v[44:47], v[112:127]
    v_exp_f32 v100, v100
    v_exp_f32 v101, v101
    v_exp_f32 v102, v102
    v_exp_f32 v103, v103
    v_smfmac_f32_32x32x32_bf16 v[176:191], a[56:59], v[80:87], v15
    v_exp_f32 v104, v104
    v_exp_f32 v105, v105
    v_exp_f32 v106, v106
    v_exp_f32 v107, v107
    v_smfmac_f32_32x32x32_bf16 v[176:191], a[60:63], v[88:95], v15
    s_waitcnt lgkmcnt(0)
    v_exp_f32 v108, v108
    v_exp_f32 v109, v109
    v_exp_f32 v110, v110
    v_exp_f32 v111, v111
    v_mfma_f32_32x32x16_bf16 v[64:79], a[48:51], v[32:35], 0
    ds_read_b128 a[56:59], v14 offset:10240
    v_exp_f32 v112, v112
    v_exp_f32 v113, v113
    v_exp_f32 v114, v114
    v_exp_f32 v115, v115
    v_mfma_f32_32x32x16_bf16 v[64:79], a[52:55], v[36:39], v[64:79]
    ds_read_b128 a[60:63], v14 offset:11264
    v_exp_f32 v116, v116
    v_exp_f32 v117, v117
    v_exp_f32 v118, v118
    v_exp_f32 v119, v119
    v_smfmac_f32_32x32x32_bf16 v[160:175], a[8:11], v[96:103], v15
    v_exp_f32 v120, v120
    v_exp_f32 v121, v121
    v_exp_f32 v122, v122
    v_exp_f32 v123, v123
    v_smfmac_f32_32x32x32_bf16 v[160:175], a[12:15], v[104:111], v15
    ds_read_b128 a[0:3], v14 offset:12288
    ds_read_b128 a[4:7], v14 offset:13312
    v_exp_f32 v124, v124
    v_exp_f32 v125, v125
    v_exp_f32 v126, v126
    v_exp_f32 v127, v127
    v_mfma_f32_32x32x16_bf16 v[80:95], a[48:51], v[40:43], 0
    v_exp_f32 v64, v64
    v_exp_f32 v65, v65
    v_exp_f32 v66, v66
    v_exp_f32 v67, v67
    v_mfma_f32_32x32x16_bf16 v[80:95], a[52:55], v[44:47], v[80:95]
    v_exp_f32 v68, v68
    v_exp_f32 v69, v69
    v_exp_f32 v70, v70
    v_exp_f32 v71, v71
    v_smfmac_f32_32x32x32_bf16 v[176:191], a[8:11], v[112:119], v15
    v_exp_f32 v72, v72
    v_exp_f32 v73, v73
    v_exp_f32 v74, v74
    v_exp_f32 v75, v75
    v_smfmac_f32_32x32x32_bf16 v[176:191], a[12:15], v[120:127], v15
    s_waitcnt lgkmcnt(0)
    v_exp_f32 v76, v76
    v_exp_f32 v77, v77
    v_exp_f32 v78, v78
    v_exp_f32 v79, v79
    v_mfma_f32_32x32x16_bf16 v[96:111], a[0:3], v[32:35], 0
    ds_read_b128 a[8:11], v14 offset:14336
    v_exp_f32 v80, v80
    v_exp_f32 v81, v81
    v_exp_f32 v82, v82
    v_exp_f32 v83, v83
    v_mfma_f32_32x32x16_bf16 v[96:111], a[4:7], v[36:39], v[96:111]
    ds_read_b128 a[12:15], v14 offset:15360
    v_exp_f32 v84, v84
    v_exp_f32 v85, v85
    v_exp_f32 v86, v86
    v_exp_f32 v87, v87
    v_smfmac_f32_32x32x32_bf16 v[160:175], a[56:59], v[64:71], v15
    v_exp_f32 v88, v88
    v_exp_f32 v89, v89
    v_exp_f32 v90, v90
    v_exp_f32 v91, v91
    v_smfmac_f32_32x32x32_bf16 v[160:175], a[60:63], v[72:79], v15
    ds_read_b128 a[48:51], v14 offset:16384
    ds_read_b128 a[52:55], v14 offset:17408
    v_exp_f32 v92, v92
    v_exp_f32 v93, v93
    v_exp_f32 v94, v94
    v_exp_f32 v95, v95
    v_mfma_f32_32x32x16_bf16 v[112:127], a[0:3], v[40:43], 0
    v_exp_f32 v96, v96
    v_exp_f32 v97, v97
    v_exp_f32 v98, v98
    v_exp_f32 v99, v99
    v_mfma_f32_32x32x16_bf16 v[112:127], a[4:7], v[44:47], v[112:127]
    v_exp_f32 v100, v100
    v_exp_f32 v101, v101
    v_exp_f32 v102, v102
    v_exp_f32 v103, v103
    v_smfmac_f32_32x32x32_bf16 v[176:191], a[56:59], v[80:87], v15
    v_exp_f32 v104, v104
    v_exp_f32 v105, v105
    v_exp_f32 v106, v106
    v_exp_f32 v107, v107
    v_smfmac_f32_32x32x32_bf16 v[176:191], a[60:63], v[88:95], v15
    s_waitcnt lgkmcnt(0)
    v_exp_f32 v108, v108
    v_exp_f32 v109, v109
    v_exp_f32 v110, v110
    v_exp_f32 v111, v111
    v_mfma_f32_32x32x16_bf16 v[64:79], a[48:51], v[32:35], 0
    ds_read_b128 a[56:59], v14 offset:18432
    v_exp_f32 v112, v112
    v_exp_f32 v113, v113
    v_exp_f32 v114, v114
    v_exp_f32 v115, v115
    v_mfma_f32_32x32x16_bf16 v[64:79], a[52:55], v[36:39], v[64:79]
    ds_read_b128 a[60:63], v14 offset:19456
    v_exp_f32 v116, v116
    v_exp_f32 v117, v117
    v_exp_f32 v118, v118
    v_exp_f32 v119, v119
    v_smfmac_f32_32x32x32_bf16 v[160:175], a[8:11], v[96:103], v15
    v_exp_f32 v120, v120
    v_exp_f32 v121, v121
    v_exp_f32 v122, v122
    v_exp_f32 v123, v123
    v_smfmac_f32_32x32x32_bf16 v[160:175], a[12:15], v[104:111], v15
    ds_read_b128 a[0:3], v14 offset:20480
    ds_read_b128 a[4:7], v14 offset:21504
    v_exp_f32 v124, v124
    v_exp_f32 v125, v125
    v_exp_f32 v126, v126
    v_exp_f32 v127, v127
    v_mfma_f32_32x32x16_bf16 v[80:95], a[48:51], v[40:43], 0
    v_exp_f32 v64, v64
    v_exp_f32 v65, v65
    v_exp_f32 v66, v66
    v_exp_f32 v67, v67
    v_mfma_f32_32x32x16_bf16 v[80:95], a[52:55], v[44:47], v[80:95]
    v_exp_f32 v68, v68
    v_exp_f32 v69, v69
    v_exp_f32 v70, v70
    v_exp_f32 v71, v71
    v_smfmac_f32_32x32x32_bf16 v[176:191], a[8:11], v[112:119], v15
    v_exp_f32 v72, v72
    v_exp_f32 v73, v73
    v_exp_f32 v74, v74
    v_exp_f32 v75, v75
    v_smfmac_f32_32x32x32_bf16 v[176:191], a[12:15], v[120:127], v15
    s_waitcnt lgkmcnt(0)
    v_exp_f32 v76, v76
    v_exp_f32 v77, v77
    v_exp_f32 v78, v78
    v_exp_f32 v79, v79
    v_mfma_f32_32x32x16_bf16 v[96:111], a[0:3], v[32:35], 0
    ds_read_b128 a[8:11], v14 offset:22528
    v_exp_f32 v80, v80
    v_exp_f32 v81, v81
    v_exp_f32 v82, v82
    v_exp_f32 v83, v83
    v_mfma_f32_32x32x16_bf16 v[96:111], a[4:7], v[36:39], v[96:111]
    ds_read_b128 a[12:15], v14 offset:23552
    v_exp_f32 v84, v84
    v_exp_f32 v85, v85
    v_exp_f32 v86, v86
    v_exp_f32 v87, v87
    v_smfmac_f32_32x32x32_bf16 v[160:175], a[56:59], v[64:71], v15
    v_exp_f32 v88, v88
    v_exp_f32 v89, v89
    v_exp_f32 v90, v90
    v_exp_f32 v91, v91
    v_smfmac_f32_32x32x32_bf16 v[160:175], a[60:63], v[72:79], v15
    ds_read_b128 a[48:51], v14 offset:24576
    ds_read_b128 a[52:55], v14 offset:25600
    v_exp_f32 v92, v92
    v_exp_f32 v93, v93
    v_exp_f32 v94, v94
    v_exp_f32 v95, v95
    v_mfma_f32_32x32x16_bf16 v[112:127], a[0:3], v[40:43], 0
    v_exp_f32 v96, v96
    v_exp_f32 v97, v97
    v_exp_f32 v98, v98
    v_exp_f32 v99, v99
    v_mfma_f32_32x32x16_bf16 v[112:127], a[4:7], v[44:47], v[112:127]
    v_exp_f32 v100, v100
    v_exp_f32 v101, v101
    v_exp_f32 v102, v102
    v_exp_f32 v103, v103
    v_smfmac_f32_32x32x32_bf16 v[176:191], a[56:59], v[80:87], v15
    v_exp_f32 v104, v104
    v_exp_f32 v105, v105
    v_exp_f32 v106, v106
    v_exp_f32 v107, v107
    v_smfmac_f32_32x32x32_bf16 v[176:191], a[60:63], v[88:95], v15
    s_waitcnt lgkmcnt(0)
    v_exp_f32 v108, v108
    v_exp_f32 v109, v109
    v_exp_f32 v110, v110
    v_exp_f32 v111, v111
    v_mfma_f32_32x32x16_bf16 v[64:79], a[48:51], v[32:35], 0
    ds_read_b128 a[56:59], v14 offset:26624
    v_exp_f32 v112, v112
    v_exp_f32 v113, v113
    v_exp_f32 v114, v114
    v_exp_f32 v115, v115
    v_mfma_f32_32x32x16_bf16 v[64:79], a[52:55], v[36:39], v[64:79]
    ds_read_b128 a[60:63], v14 offset:27648
    v_exp_f32 v116, v116
    v_exp_f32 v117, v117
    v_exp_f32 v118, v118
    v_exp_f32 v119, v119
    v_smfmac_f32_32x32x32_bf16 v[160:175], a[8:11], v[96:103], v15
    v_exp_f32 v120, v120
    v_exp_f32 v121, v121
    v_exp_f32 v122, v122
    v_exp_f32 v123, v123
    v_smfmac_f32_32x32x32_bf16 v[160:175], a[12:15], v[104:111], v15
    ds_read_b128 a[0:3], v14 offset:28672
    ds_read_b128 a[4:7], v14 offset:29696
    v_exp_f32 v124, v124
    v_exp_f32 v125, v125
    v_exp_f32 v126, v126
    v_exp_f32 v127, v127
    v_mfma_f32_32x32x16_bf16 v[80:95], a[48:51], v[40:43], 0
    v_exp_f32 v64, v64
    v_exp_f32 v65, v65
    v_exp_f32 v66, v66
    v_exp_f32 v67, v67
    v_mfma_f32_32x32x16_bf16 v[80:95], a[52:55], v[44:47], v[80:95]
    v_exp_f32 v68, v68
    v_exp_f32 v69, v69
    v_exp_f32 v70, v70
    v_exp_f32 v71, v71
    v_smfmac_f32_32x32x32_bf16 v[176:191], a[8:11], v[112:119], v15
    v_exp_f32 v72, v72
    v_exp_f32 v73, v73
    v_exp_f32 v74, v74
    v_exp_f32 v75, v75
    v_smfmac_f32_32x32x32_bf16 v[176:191], a[12:15], v[120:127], v15
    s_waitcnt lgkmcnt(0)
    v_exp_f32 v76, v76
    v_exp_f32 v77, v77
    v_exp_f32 v78, v78
    v_exp_f32 v79, v79
    v_mfma_f32_32x32x16_bf16 v[96:111], a[0:3], v[32:35], 0
    ds_read_b128 a[8:11], v14 offset:30720
    v_exp_f32 v80, v80
    v_exp_f32 v81, v81
    v_exp_f32 v82, v82
    v_exp_f32 v83, v83
    v_mfma_f32_32x32x16_bf16 v[96:111], a[4:7], v[36:39], v[96:111]
    ds_read_b128 a[12:15], v14 offset:31744
    v_exp_f32 v84, v84
    v_exp_f32 v85, v85
    v_exp_f32 v86, v86
    v_exp_f32 v87, v87
    v_smfmac_f32_32x32x32_bf16 v[160:175], a[56:59], v[64:71], v15
    s_waitcnt lgkmcnt(0)
    s_barrier
    v_exp_f32 v88, v88
    v_exp_f32 v89, v89
    v_exp_f32 v90, v90
    v_exp_f32 v91, v91
    v_smfmac_f32_32x32x32_bf16 v[160:175], a[60:63], v[72:79], v15
    ds_read_b128 a[48:51], v2 offset:0
    ds_read_b128 a[52:55], v2 offset:1024
    v_exp_f32 v92, v92
    v_exp_f32 v93, v93
    v_exp_f32 v94, v94
    v_exp_f32 v95, v95
    v_mfma_f32_32x32x16_bf16 v[112:127], a[0:3], v[40:43], 0
    v_exp_f32 v96, v96
    v_exp_f32 v97, v97
    v_exp_f32 v98, v98
    v_exp_f32 v99, v99
    v_mfma_f32_32x32x16_bf16 v[112:127], a[4:7], v[44:47], v[112:127]
    v_exp_f32 v100, v100
    v_exp_f32 v101, v101
    v_exp_f32 v102, v102
    v_exp_f32 v103, v103
    v_smfmac_f32_32x32x32_bf16 v[176:191], a[56:59], v[80:87], v15
    v_exp_f32 v104, v104
    v_exp_f32 v105, v105
    v_exp_f32 v106, v106
    v_exp_f32 v107, v107
    v_smfmac_f32_32x32x32_bf16 v[176:191], a[60:63], v[88:95], v15
    s_waitcnt lgkmcnt(0)
    v_exp_f32 v108, v108
    v_exp_f32 v109, v109
    v_exp_f32 v110, v110
    v_exp_f32 v111, v111
    v_mfma_f32_32x32x16_bf16 v[64:79], a[48:51], v[32:35], 0
    ds_read_b128 a[56:59], v2 offset:2048
    v_exp_f32 v112, v112
    v_exp_f32 v113, v113
    v_exp_f32 v114, v114
    v_exp_f32 v115, v115
    v_mfma_f32_32x32x16_bf16 v[64:79], a[52:55], v[36:39], v[64:79]
    ds_read_b128 a[60:63], v2 offset:3072
    v_exp_f32 v116, v116
    v_exp_f32 v117, v117
    v_exp_f32 v118, v118
    v_exp_f32 v119, v119
    v_smfmac_f32_32x32x32_bf16 v[160:175], a[8:11], v[96:103], v15
    v_exp_f32 v120, v120
    v_exp_f32 v121, v121
    v_exp_f32 v122, v122
    v_exp_f32 v123, v123
    v_smfmac_f32_32x32x32_bf16 v[160:175], a[12:15], v[104:111], v15
    ds_read_b128 a[0:3], v2 offset:4096
    ds_read_b128 a[4:7], v2 offset:5120
    v_exp_f32 v124, v124
    v_exp_f32 v125, v125
    v_exp_f32 v126, v126
    v_exp_f32 v127, v127
    v_mfma_f32_32x32x16_bf16 v[80:95], a[48:51], v[40:43], 0
    v_exp_f32 v64, v64
    v_exp_f32 v65, v65
    v_exp_f32 v66, v66
    v_exp_f32 v67, v67
    v_mfma_f32_32x32x16_bf16 v[80:95], a[52:55], v[44:47], v[80:95]
    v_exp_f32 v68, v68
    v_exp_f32 v69, v69
    v_exp_f32 v70, v70
    v_exp_f32 v71, v71
    v_smfmac_f32_32x32x32_bf16 v[176:191], a[8:11], v[112:119], v15
    v_exp_f32 v72, v72
    v_exp_f32 v73, v73
    v_exp_f32 v74, v74
    v_exp_f32 v75, v75
    v_smfmac_f32_32x32x32_bf16 v[176:191], a[12:15], v[120:127], v15
    s_waitcnt lgkmcnt(0)
    v_exp_f32 v76, v76
    v_exp_f32 v77, v77
    v_exp_f32 v78, v78
    v_exp_f32 v79, v79
    v_mfma_f32_32x32x16_bf16 v[96:111], a[0:3], v[32:35], 0
    ds_read_b128 a[8:11], v2 offset:6144
    v_exp_f32 v80, v80
    v_exp_f32 v81, v81
    v_exp_f32 v82, v82
    v_exp_f32 v83, v83
    v_mfma_f32_32x32x16_bf16 v[96:111], a[4:7], v[36:39], v[96:111]
    ds_read_b128 a[12:15], v2 offset:7168
    v_exp_f32 v84, v84
    v_exp_f32 v85, v85
    v_exp_f32 v86, v86
    v_exp_f32 v87, v87
    v_smfmac_f32_32x32x32_bf16 v[160:175], a[56:59], v[64:71], v15
    v_exp_f32 v88, v88
    v_exp_f32 v89, v89
    v_exp_f32 v90, v90
    v_exp_f32 v91, v91
    v_smfmac_f32_32x32x32_bf16 v[160:175], a[60:63], v[72:79], v15
    ds_read_b128 a[48:51], v2 offset:8192
    ds_read_b128 a[52:55], v2 offset:9216
    v_exp_f32 v92, v92
    v_exp_f32 v93, v93
    v_exp_f32 v94, v94
    v_exp_f32 v95, v95
    v_mfma_f32_32x32x16_bf16 v[112:127], a[0:3], v[40:43], 0
    v_exp_f32 v96, v96
    v_exp_f32 v97, v97
    v_exp_f32 v98, v98
    v_exp_f32 v99, v99
    v_mfma_f32_32x32x16_bf16 v[112:127], a[4:7], v[44:47], v[112:127]
    v_exp_f32 v100, v100
    v_exp_f32 v101, v101
    v_exp_f32 v102, v102
    v_exp_f32 v103, v103
    v_smfmac_f32_32x32x32_bf16 v[176:191], a[56:59], v[80:87], v15
    v_exp_f32 v104, v104
    v_exp_f32 v105, v105
    v_exp_f32 v106, v106
    v_exp_f32 v107, v107
    v_smfmac_f32_32x32x32_bf16 v[176:191], a[60:63], v[88:95], v15
    s_waitcnt lgkmcnt(0)
    v_exp_f32 v108, v108
    v_exp_f32 v109, v109
    v_exp_f32 v110, v110
    v_exp_f32 v111, v111
    v_mfma_f32_32x32x16_bf16 v[64:79], a[48:51], v[32:35], 0
    ds_read_b128 a[56:59], v2 offset:10240
    v_exp_f32 v112, v112
    v_exp_f32 v113, v113
    v_exp_f32 v114, v114
    v_exp_f32 v115, v115
    v_mfma_f32_32x32x16_bf16 v[64:79], a[52:55], v[36:39], v[64:79]
    ds_read_b128 a[60:63], v2 offset:11264
    v_exp_f32 v116, v116
    v_exp_f32 v117, v117
    v_exp_f32 v118, v118
    v_exp_f32 v119, v119
    v_smfmac_f32_32x32x32_bf16 v[160:175], a[8:11], v[96:103], v15
    v_exp_f32 v120, v120
    v_exp_f32 v121, v121
    v_exp_f32 v122, v122
    v_exp_f32 v123, v123
    v_smfmac_f32_32x32x32_bf16 v[160:175], a[12:15], v[104:111], v15
    ds_read_b128 a[0:3], v2 offset:12288
    ds_read_b128 a[4:7], v2 offset:13312
    v_exp_f32 v124, v124
    v_exp_f32 v125, v125
    v_exp_f32 v126, v126
    v_exp_f32 v127, v127
    v_mfma_f32_32x32x16_bf16 v[80:95], a[48:51], v[40:43], 0
    v_exp_f32 v64, v64
    v_exp_f32 v65, v65
    v_exp_f32 v66, v66
    v_exp_f32 v67, v67
    v_mfma_f32_32x32x16_bf16 v[80:95], a[52:55], v[44:47], v[80:95]
    v_exp_f32 v68, v68
    v_exp_f32 v69, v69
    v_exp_f32 v70, v70
    v_exp_f32 v71, v71
    v_smfmac_f32_32x32x32_bf16 v[176:191], a[8:11], v[112:119], v15
    v_exp_f32 v72, v72
    v_exp_f32 v73, v73
    v_exp_f32 v74, v74
    v_exp_f32 v75, v75
    v_smfmac_f32_32x32x32_bf16 v[176:191], a[12:15], v[120:127], v15
    s_waitcnt lgkmcnt(0)
    v_exp_f32 v76, v76
    v_exp_f32 v77, v77
    v_exp_f32 v78, v78
    v_exp_f32 v79, v79
    v_mfma_f32_32x32x16_bf16 v[96:111], a[0:3], v[32:35], 0
    ds_read_b128 a[8:11], v2 offset:14336
    v_exp_f32 v80, v80
    v_exp_f32 v81, v81
    v_exp_f32 v82, v82
    v_exp_f32 v83, v83
    v_mfma_f32_32x32x16_bf16 v[96:111], a[4:7], v[36:39], v[96:111]
    ds_read_b128 a[12:15], v2 offset:15360
    v_exp_f32 v84, v84
    v_exp_f32 v85, v85
    v_exp_f32 v86, v86
    v_exp_f32 v87, v87
    v_smfmac_f32_32x32x32_bf16 v[160:175], a[56:59], v[64:71], v15
    v_exp_f32 v88, v88
    v_exp_f32 v89, v89
    v_exp_f32 v90, v90
    v_exp_f32 v91, v91
    v_smfmac_f32_32x32x32_bf16 v[160:175], a[60:63], v[72:79], v15
    ds_read_b128 a[48:51], v2 offset:16384
    ds_read_b128 a[52:55], v2 offset:17408
    v_exp_f32 v92, v92
    v_exp_f32 v93, v93
    v_exp_f32 v94, v94
    v_exp_f32 v95, v95
    v_mfma_f32_32x32x16_bf16 v[112:127], a[0:3], v[40:43], 0
    v_exp_f32 v96, v96
    v_exp_f32 v97, v97
    v_exp_f32 v98, v98
    v_exp_f32 v99, v99
    v_mfma_f32_32x32x16_bf16 v[112:127], a[4:7], v[44:47], v[112:127]
    v_exp_f32 v100, v100
    v_exp_f32 v101, v101
    v_exp_f32 v102, v102
    v_exp_f32 v103, v103
    v_smfmac_f32_32x32x32_bf16 v[176:191], a[56:59], v[80:87], v15
    v_exp_f32 v104, v104
    v_exp_f32 v105, v105
    v_exp_f32 v106, v106
    v_exp_f32 v107, v107
    v_smfmac_f32_32x32x32_bf16 v[176:191], a[60:63], v[88:95], v15
    s_waitcnt lgkmcnt(0)
    v_exp_f32 v108, v108
    v_exp_f32 v109, v109
    v_exp_f32 v110, v110
    v_exp_f32 v111, v111
    v_mfma_f32_32x32x16_bf16 v[64:79], a[48:51], v[32:35], 0
    ds_read_b128 a[56:59], v2 offset:18432
    v_exp_f32 v112, v112
    v_exp_f32 v113, v113
    v_exp_f32 v114, v114
    v_exp_f32 v115, v115
    v_mfma_f32_32x32x16_bf16 v[64:79], a[52:55], v[36:39], v[64:79]
    ds_read_b128 a[60:63], v2 offset:19456
    v_exp_f32 v116, v116
    v_exp_f32 v117, v117
    v_exp_f32 v118, v118
    v_exp_f32 v119, v119
    v_smfmac_f32_32x32x32_bf16 v[160:175], a[8:11], v[96:103], v15
    v_exp_f32 v120, v120
    v_exp_f32 v121, v121
    v_exp_f32 v122, v122
    v_exp_f32 v123, v123
    v_smfmac_f32_32x32x32_bf16 v[160:175], a[12:15], v[104:111], v15
    ds_read_b128 a[0:3], v2 offset:20480
    ds_read_b128 a[4:7], v2 offset:21504
    v_exp_f32 v124, v124
    v_exp_f32 v125, v125
    v_exp_f32 v126, v126
    v_exp_f32 v127, v127
    v_mfma_f32_32x32x16_bf16 v[80:95], a[48:51], v[40:43], 0
    v_exp_f32 v64, v64
    v_exp_f32 v65, v65
    v_exp_f32 v66, v66
    v_exp_f32 v67, v67
    v_mfma_f32_32x32x16_bf16 v[80:95], a[52:55], v[44:47], v[80:95]
    v_exp_f32 v68, v68
    v_exp_f32 v69, v69
    v_exp_f32 v70, v70
    v_exp_f32 v71, v71
    v_smfmac_f32_32x32x32_bf16 v[176:191], a[8:11], v[112:119], v15
    v_exp_f32 v72, v72
    v_exp_f32 v73, v73
    v_exp_f32 v74, v74
    v_exp_f32 v75, v75
    v_smfmac_f32_32x32x32_bf16 v[176:191], a[12:15], v[120:127], v15
    s_waitcnt lgkmcnt(0)
    v_exp_f32 v76, v76
    v_exp_f32 v77, v77
    v_exp_f32 v78, v78
    v_exp_f32 v79, v79
    v_mfma_f32_32x32x16_bf16 v[96:111], a[0:3], v[32:35], 0
    ds_read_b128 a[8:11], v2 offset:22528
    v_exp_f32 v80, v80
    v_exp_f32 v81, v81
    v_exp_f32 v82, v82
    v_exp_f32 v83, v83
    v_mfma_f32_32x32x16_bf16 v[96:111], a[4:7], v[36:39], v[96:111]
    ds_read_b128 a[12:15], v2 offset:23552
    v_exp_f32 v84, v84
    v_exp_f32 v85, v85
    v_exp_f32 v86, v86
    v_exp_f32 v87, v87
    v_smfmac_f32_32x32x32_bf16 v[160:175], a[56:59], v[64:71], v15
    v_exp_f32 v88, v88
    v_exp_f32 v89, v89
    v_exp_f32 v90, v90
    v_exp_f32 v91, v91
    v_smfmac_f32_32x32x32_bf16 v[160:175], a[60:63], v[72:79], v15
    ds_read_b128 a[48:51], v2 offset:24576
    ds_read_b128 a[52:55], v2 offset:25600
    v_exp_f32 v92, v92
    v_exp_f32 v93, v93
    v_exp_f32 v94, v94
    v_exp_f32 v95, v95
    v_mfma_f32_32x32x16_bf16 v[112:127], a[0:3], v[40:43], 0
    v_exp_f32 v96, v96
    v_exp_f32 v97, v97
    v_exp_f32 v98, v98
    v_exp_f32 v99, v99
    v_mfma_f32_32x32x16_bf16 v[112:127], a[4:7], v[44:47], v[112:127]
    v_exp_f32 v100, v100
    v_exp_f32 v101, v101
    v_exp_f32 v102, v102
    v_exp_f32 v103, v103
    v_smfmac_f32_32x32x32_bf16 v[176:191], a[56:59], v[80:87], v15
    v_exp_f32 v104, v104
    v_exp_f32 v105, v105
    v_exp_f32 v106, v106
    v_exp_f32 v107, v107
    v_smfmac_f32_32x32x32_bf16 v[176:191], a[60:63], v[88:95], v15
    s_waitcnt lgkmcnt(0)
    v_exp_f32 v108, v108
    v_exp_f32 v109, v109
    v_exp_f32 v110, v110
    v_exp_f32 v111, v111
    v_mfma_f32_32x32x16_bf16 v[64:79], a[48:51], v[32:35], 0
    ds_read_b128 a[56:59], v2 offset:26624
    v_exp_f32 v112, v112
    v_exp_f32 v113, v113
    v_exp_f32 v114, v114
    v_exp_f32 v115, v115
    v_mfma_f32_32x32x16_bf16 v[64:79], a[52:55], v[36:39], v[64:79]
    ds_read_b128 a[60:63], v2 offset:27648
    v_exp_f32 v116, v116
    v_exp_f32 v117, v117
    v_exp_f32 v118, v118
    v_exp_f32 v119, v119
    v_smfmac_f32_32x32x32_bf16 v[160:175], a[8:11], v[96:103], v15
    v_exp_f32 v120, v120
    v_exp_f32 v121, v121
    v_exp_f32 v122, v122
    v_exp_f32 v123, v123
    v_smfmac_f32_32x32x32_bf16 v[160:175], a[12:15], v[104:111], v15
    ds_read_b128 a[0:3], v2 offset:28672
    ds_read_b128 a[4:7], v2 offset:29696
    v_exp_f32 v124, v124
    v_exp_f32 v125, v125
    v_exp_f32 v126, v126
    v_exp_f32 v127, v127
    v_mfma_f32_32x32x16_bf16 v[80:95], a[48:51], v[40:43], 0
    v_exp_f32 v64, v64
    v_exp_f32 v65, v65
    v_exp_f32 v66, v66
    v_exp_f32 v67, v67
    v_mfma_f32_32x32x16_bf16 v[80:95], a[52:55], v[44:47], v[80:95]
    v_exp_f32 v68, v68
    v_exp_f32 v69, v69
    v_exp_f32 v70, v70
    v_exp_f32 v71, v71
    v_smfmac_f32_32x32x32_bf16 v[176:191], a[8:11], v[112:119], v15
    v_exp_f32 v72, v72
    v_exp_f32 v73, v73
    v_exp_f32 v74, v74
    v_exp_f32 v75, v75
    v_smfmac_f32_32x32x32_bf16 v[176:191], a[12:15], v[120:127], v15
    s_waitcnt lgkmcnt(0)
    v_exp_f32 v76, v76
    v_exp_f32 v77, v77
    v_exp_f32 v78, v78
    v_exp_f32 v79, v79
    v_mfma_f32_32x32x16_bf16 v[96:111], a[0:3], v[32:35], 0
    ds_read_b128 a[8:11], v2 offset:30720
    v_exp_f32 v80, v80
    v_exp_f32 v81, v81
    v_exp_f32 v82, v82
    v_exp_f32 v83, v83
    v_mfma_f32_32x32x16_bf16 v[96:111], a[4:7], v[36:39], v[96:111]
    ds_read_b128 a[12:15], v2 offset:31744
    v_exp_f32 v84, v84
    v_exp_f32 v85, v85
    v_exp_f32 v86, v86
    v_exp_f32 v87, v87
    v_smfmac_f32_32x32x32_bf16 v[160:175], a[56:59], v[64:71], v15
    s_waitcnt lgkmcnt(0)
    s_barrier
    v_exp_f32 v88, v88
    v_exp_f32 v89, v89
    v_exp_f32 v90, v90
    v_exp_f32 v91, v91
    v_smfmac_f32_32x32x32_bf16 v[160:175], a[60:63], v[72:79], v15
    ds_read_b128 a[48:51], v2 offset:32768
    ds_read_b128 a[52:55], v2 offset:33792
    v_exp_f32 v92, v92
    v_exp_f32 v93, v93
    v_exp_f32 v94, v94
    v_exp_f32 v95, v95
    v_mfma_f32_32x32x16_bf16 v[112:127], a[0:3], v[40:43], 0
    v_exp_f32 v96, v96
    v_exp_f32 v97, v97
    v_exp_f32 v98, v98
    v_exp_f32 v99, v99
    v_mfma_f32_32x32x16_bf16 v[112:127], a[4:7], v[44:47], v[112:127]
    v_exp_f32 v100, v100
    v_exp_f32 v101, v101
    v_exp_f32 v102, v102
    v_exp_f32 v103, v103
    v_smfmac_f32_32x32x32_bf16 v[176:191], a[56:59], v[80:87], v15
    v_exp_f32 v104, v104
    v_exp_f32 v105, v105
    v_exp_f32 v106, v106
    v_exp_f32 v107, v107
    v_smfmac_f32_32x32x32_bf16 v[176:191], a[60:63], v[88:95], v15
    s_waitcnt lgkmcnt(0)
    v_exp_f32 v108, v108
    v_exp_f32 v109, v109
    v_exp_f32 v110, v110
    v_exp_f32 v111, v111
    v_mfma_f32_32x32x16_bf16 v[64:79], a[48:51], v[32:35], 0
    ds_read_b128 a[56:59], v2 offset:34816
    v_exp_f32 v112, v112
    v_exp_f32 v113, v113
    v_exp_f32 v114, v114
    v_exp_f32 v115, v115
    v_mfma_f32_32x32x16_bf16 v[64:79], a[52:55], v[36:39], v[64:79]
    ds_read_b128 a[60:63], v2 offset:35840
    v_exp_f32 v116, v116
    v_exp_f32 v117, v117
    v_exp_f32 v118, v118
    v_exp_f32 v119, v119
    v_smfmac_f32_32x32x32_bf16 v[160:175], a[8:11], v[96:103], v15
    v_exp_f32 v120, v120
    v_exp_f32 v121, v121
    v_exp_f32 v122, v122
    v_exp_f32 v123, v123
    v_smfmac_f32_32x32x32_bf16 v[160:175], a[12:15], v[104:111], v15
    ds_read_b128 a[0:3], v2 offset:36864
    ds_read_b128 a[4:7], v2 offset:37888
    v_exp_f32 v124, v124
    v_exp_f32 v125, v125
    v_exp_f32 v126, v126
    v_exp_f32 v127, v127
    v_mfma_f32_32x32x16_bf16 v[80:95], a[48:51], v[40:43], 0
    v_exp_f32 v64, v64
    v_exp_f32 v65, v65
    v_exp_f32 v66, v66
    v_exp_f32 v67, v67
    v_mfma_f32_32x32x16_bf16 v[80:95], a[52:55], v[44:47], v[80:95]
    v_exp_f32 v68, v68
    v_exp_f32 v69, v69
    v_exp_f32 v70, v70
    v_exp_f32 v71, v71
    v_smfmac_f32_32x32x32_bf16 v[176:191], a[8:11], v[112:119], v15
L_pad5:
    s_cbranch_execz L_padret5
    v_exp_f32 v72, v72
    v_exp_f32 v73, v73
    v_exp_f32 v74, v74
    v_exp_f32 v75, v75
    v_smfmac_f32_32x32x32_bf16 v[176:191], a[12:15], v[120:127], v15
    s_waitcnt lgkmcnt(0)
    v_exp_f32 v76, v76
    v_exp_f32 v77, v77
    v_exp_f32 v78, v78
    v_exp_f32 v79, v79
    v_mfma_f32_32x32x16_bf16 v[96:111], a[0:3], v[32:35], 0
    ds_read_b128 a[8:11], v2 offset:38912
    v_exp_f32 v80, v80
    v_exp_f32 v81, v81
    v_exp_f32 v82, v82
    v_exp_f32 v83, v83
    v_mfma_f32_32x32x16_bf16 v[96:111], a[4:7], v[36:39], v[96:111]
    ds_read_b128 a[12:15], v2 offset:39936
    v_exp_f32 v84, v84
    v_exp_f32 v85, v85
    v_exp_f32 v86, v86
    v_exp_f32 v87, v87
    v_smfmac_f32_32x32x32_bf16 v[160:175], a[56:59], v[64:71], v15
    v_exp_f32 v88, v88
    v_exp_f32 v89, v89
    v_exp_f32 v90, v90
    v_exp_f32 v91, v91
    v_smfmac_f32_32x32x32_bf16 v[160:175], a[60:63], v[72:79], v15
    ds_read_b128 a[48:51], v2 offset:40960
    ds_read_b128 a[52:55], v2 offset:41984
    v_exp_f32 v92, v92
    v_exp_f32 v93, v93
    v_exp_f32 v94, v94
    v_exp_f32 v95, v95
    v_mfma_f32_32x32x16_bf16 v[112:127], a[0:3], v[40:43], 0
    v_exp_f32 v96, v96
    v_exp_f32 v97, v97
    v_exp_f32 v98, v98
    v_exp_f32 v99, v99
    v_mfma_f32_32x32x16_bf16 v[112:127], a[4:7], v[44:47], v[112:127]
    v_exp_f32 v100, v100
    v_exp_f32 v101, v101
    v_exp_f32 v102, v102
    v_exp_f32 v103, v103
    v_smfmac_f32_32x32x32_bf16 v[176:191], a[56:59], v[80:87], v15
    v_exp_f32 v104, v104
    v_exp_f32 v105, v105
    v_exp_f32 v106, v106
    v_exp_f32 v107, v107
    v_smfmac_f32_32x32x32_bf16 v[176:191], a[60:63], v[88:95], v15
    s_waitcnt lgkmcnt(0)
    v_exp_f32 v108, v108
    v_exp_f32 v109, v109
    v_exp_f32 v110, v110
    v_exp_f32 v111, v111
    v_mfma_f32_32x32x16_bf16 v[64:79], a[48:51], v[32:35], 0
    ds_read_b128 a[56:59], v2 offset:43008
    v_exp_f32 v112, v112
    v_exp_f32 v113, v113
    v_exp_f32 v114, v114
    v_exp_f32 v115, v115
    v_mfma_f32_32x32x16_bf16 v[64:79], a[52:55], v[36:39], v[64:79]
    ds_read_b128 a[60:63], v2 offset:44032
    v_exp_f32 v116, v116
    v_exp_f32 v117, v117
    v_exp_f32 v118, v118
    v_exp_f32 v119, v119
    v_smfmac_f32_32x32x32_bf16 v[160:175], a[8:11], v[96:103], v15
    v_exp_f32 v120, v120
    v_exp_f32 v121, v121
    v_exp_f32 v122, v122
    v_exp_f32 v123, v123
    v_smfmac_f32_32x32x32_bf16 v[160:175], a[12:15], v[104:111], v15
    ds_read_b128 a[0:3], v2 offset:45056
    ds_read_b128 a[4:7], v2 offset:46080
    v_exp_f32 v124, v124
    v_exp_f32 v125, v125
    v_exp_f32 v126, v126
    v_exp_f32 v127, v127
    v_mfma_f32_32x32x16_bf16 v[80:95], a[48:51], v[40:43], 0
    v_exp_f32 v64, v64
    v_exp_f32 v65, v65
    v_exp_f32 v66, v66
    v_exp_f32 v67, v67
    v_mfma_f32_32x32x16_bf16 v[80:95], a[52:55], v[44:47], v[80:95]
    v_exp_f32 v68, v68
    v_exp_f32 v69, v69
    v_exp_f32 v70, v70
    v_exp_f32 v71, v71
    v_smfmac_f32_32x32x32_bf16 v[176:191], a[8:11], v[112:119], v15
    v_exp_f32 v72, v72
    v_exp_f32 v73, v73
    v_exp_f32 v74, v74
    v_exp_f32 v75, v75
    v_smfmac_f32_32x32x32_bf16 v[176:191], a[12:15], v[120:127], v15
    s_waitcnt lgkmcnt(0)
    v_exp_f32 v76, v76
    v_exp_f32 v77, v77
    v_exp_f32 v78, v78
    v_exp_f32 v79, v79
    v_mfma_f32_32x32x16_bf16 v[96:111], a[0:3], v[32:35], 0
    ds_read_b128 a[8:11], v2 offset:47104
    v_exp_f32 v80, v80
    v_exp_f32 v81, v81
    v_exp_f32 v82, v82
    v_exp_f32 v83, v83
    v_mfma_f32_32x32x16_bf16 v[96:111], a[4:7], v[36:39], v[96:111]
    ds_read_b128 a[12:15], v2 offset:48128
    v_exp_f32 v84, v84
    v_exp_f32 v85, v85
    v_exp_f32 v86, v86
    v_exp_f32 v87, v87
    v_smfmac_f32_32x32x32_bf16 v[160:175], a[56:59], v[64:71], v15
    v_exp_f32 v88, v88
    v_exp_f32 v89, v89
    v_exp_f32 v90, v90
    v_exp_f32 v91, v91
    v_smfmac_f32_32x32x32_bf16 v[160:175], a[60:63], v[72:79], v15
    ds_read_b128 a[48:51], v2 offset:49152
    ds_read_b128 a[52:55], v2 offset:50176
    v_exp_f32 v92, v92
    v_exp_f32 v93, v93
    v_exp_f32 v94, v94
    v_exp_f32 v95, v95
    v_mfma_f32_32x32x16_bf16 v[112:127], a[0:3], v[40:43], 0
    v_exp_f32 v96, v96
    v_exp_f32 v97, v97
    v_exp_f32 v98, v98
    v_exp_f32 v99, v99
    v_mfma_f32_32x32x16_bf16 v[112:127], a[4:7], v[44:47], v[112:127]
    v_exp_f32 v100, v100
    v_exp_f32 v101, v101
    v_exp_f32 v102, v102
    v_exp_f32 v103, v103
    v_smfmac_f32_32x32x32_bf16 v[176:191], a[56:59], v[80:87], v15
    v_exp_f32 v104, v104
    v_exp_f32 v105, v105
    v_exp_f32 v106, v106
    v_exp_f32 v107, v107
    v_smfmac_f32_32x32x32_bf16 v[176:191], a[60:63], v[88:95], v15
    s_waitcnt lgkmcnt(0)
    v_exp_f32 v108, v108
    v_exp_f32 v109, v109
    v_exp_f32 v110, v110
    v_exp_f32 v111, v111
    v_mfma_f32_32x32x16_bf16 v[64:79], a[48:51], v[32:35], 0
    ds_read_b128 a[56:59], v2 offset:51200
    v_exp_f32 v112, v112
    v_exp_f32 v113, v113
    v_exp_f32 v114, v114
    v_exp_f32 v115, v115
    v_mfma_f32_32x32x16_bf16 v[64:79], a[52:55], v[36:39], v[64:79]
    ds_read_b128 a[60:63], v2 offset:52224
    v_exp_f32 v116, v116
    v_exp_f32 v117, v117
    v_exp_f32 v118, v118
    v_exp_f32 v119, v119
    v_smfmac_f32_32x32x32_bf16 v[160:175], a[8:11], v[96:103], v15
    v_exp_f32 v120, v120
    v_exp_f32 v121, v121
    v_exp_f32 v122, v122
    v_exp_f32 v123, v123
    v_smfmac_f32_32x32x32_bf16 v[160:175], a[12:15], v[104:111], v15
    ds_read_b128 a[0:3], v2 offset:53248
    ds_read_b128 a[4:7], v2 offset:54272
    v_exp_f32 v124, v124
    v_exp_f32 v125, v125
    v_exp_f32 v126, v126
    v_exp_f32 v127, v127
    v_mfma_f32_32x32x16_bf16 v[80:95], a[48:51], v[40:43], 0
    v_exp_f32 v64, v64
    v_exp_f32 v65, v65
    v_exp_f32 v66, v66
    v_exp_f32 v67, v67
    v_mfma_f32_32x32x16_bf16 v[80:95], a[52:55], v[44:47], v[80:95]
    v_exp_f32 v68, v68
    v_exp_f32 v69, v69
    v_exp_f32 v70, v70
    v_exp_f32 v71, v71
    v_smfmac_f32_32x32x32_bf16 v[176:191], a[8:11], v[112:119], v15
    v_exp_f32 v72, v72
    v_exp_f32 v73, v73
    v_exp_f32 v74, v74
    v_exp_f32 v75, v75
    v_smfmac_f32_32x32x32_bf16 v[176:191], a[12:15], v[120:127], v15
    s_waitcnt lgkmcnt(0)
    v_exp_f32 v76, v76
    v_exp_f32 v77, v77
    v_exp_f32 v78, v78
    v_exp_f32 v79, v79
    v_mfma_f32_32x32x16_bf16 v[96:111], a[0:3], v[32:35], 0
    ds_read_b128 a[8:11], v2 offset:55296
    v_exp_f32 v80, v80
    v_exp_f32 v81, v81
    v_exp_f32 v82, v82
    v_exp_f32 v83, v83
    v_mfma_f32_32x32x16_bf16 v[96:111], a[4:7], v[36:39], v[96:111]
    ds_read_b128 a[12:15], v2 offset:56320
    v_exp_f32 v84, v84
    v_exp_f32 v85, v85
    v_exp_f32 v86, v86
    v_exp_f32 v87, v87
    v_smfmac_f32_32x32x32_bf16 v[160:175], a[56:59], v[64:71], v15
    v_exp_f32 v88, v88
    v_exp_f32 v89, v89
    v_exp_f32 v90, v90
    v_exp_f32 v91, v91
    v_smfmac_f32_32x32x32_bf16 v[160:175], a[60:63], v[72:79], v15
    ds_read_b128 a[48:51], v2 offset:57344
    ds_read_b128 a[52:55], v2 offset:58368
    v_exp_f32 v92, v92
    v_exp_f32 v93, v93
    v_exp_f32 v94, v94
    v_exp_f32 v95, v95
    v_mfma_f32_32x32x16_bf16 v[112:127], a[0:3], v[40:43], 0
    v_exp_f32 v96, v96
    v_exp_f32 v97, v97
    v_exp_f32 v98, v98
    v_exp_f32 v99, v99
    v_mfma_f32_32x32x16_bf16 v[112:127], a[4:7], v[44:47], v[112:127]
    v_exp_f32 v100, v100
    v_exp_f32 v101, v101
    v_exp_f32 v102, v102
    v_exp_f32 v103, v103
    v_smfmac_f32_32x32x32_bf16 v[176:191], a[56:59], v[80:87], v15
    v_exp_f32 v104, v104
    v_exp_f32 v105, v105
    v_exp_f32 v106, v106
    v_exp_f32 v107, v107
    v_smfmac_f32_32x32x32_bf16 v[176:191], a[60:63], v[88:95], v15
    s_waitcnt lgkmcnt(0)
    v_exp_f32 v108, v108
    v_exp_f32 v109, v109
    v_exp_f32 v110, v110
    v_exp_f32 v111, v111
    v_mfma_f32_32x32x16_bf16 v[64:79], a[48:51], v[32:35], 0
    ds_read_b128 a[56:59], v2 offset:59392
    v_exp_f32 v112, v112
    v_exp_f32 v113, v113
    v_exp_f32 v114, v114
    v_exp_f32 v115, v115
    v_mfma_f32_32x32x16_bf16 v[64:79], a[52:55], v[36:39], v[64:79]
    ds_read_b128 a[60:63], v2 offset:60416
    v_exp_f32 v116, v116
    v_exp_f32 v117, v117
    v_exp_f32 v118, v118
    v_exp_f32 v119, v119
    v_smfmac_f32_32x32x32_bf16 v[160:175], a[8:11], v[96:103], v15
    v_exp_f32 v120, v120
    v_exp_f32 v121, v121
    v_exp_f32 v122, v122
    v_exp_f32 v123, v123
    v_smfmac_f32_32x32x32_bf16 v[160:175], a[12:15], v[104:111], v15
    ds_read_b128 a[0:3], v2 offset:61440
    ds_read_b128 a[4:7], v2 offset:62464
    v_exp_f32 v124, v124
    v_exp_f32 v125, v125
    v_exp_f32 v126, v126
    v_exp_f32 v127, v127
    v_mfma_f32_32x32x16_bf16 v[80:95], a[48:51], v[40:43], 0
    v_exp_f32 v64, v64
    v_exp_f32 v65, v65
    v_exp_f32 v66, v66
    v_exp_f32 v67, v67
    v_mfma_f32_32x32x16_bf16 v[80:95], a[52:55], v[44:47], v[80:95]
    v_exp_f32 v68, v68
    v_exp_f32 v69, v69
    v_exp_f32 v70, v70
    v_exp_f32 v71, v71
    v_smfmac_f32_32x32x32_bf16 v[176:191], a[8:11], v[112:119], v15
    v_exp_f32 v72, v72
    v_exp_f32 v73, v73
    v_exp_f32 v74, v74
    v_exp_f32 v75, v75
    v_smfmac_f32_32x32x32_bf16 v[176:191], a[12:15], v[120:127], v15
    s_waitcnt lgkmcnt(0)
    v_exp_f32 v76, v76
    v_exp_f32 v77, v77
    v_exp_f32 v78, v78
    v_exp_f32 v79, v79
    v_mfma_f32_32x32x16_bf16 v[96:111], a[0:3], v[32:35], 0
    ds_read_b128 a[8:11], v2 offset:63488
    v_exp_f32 v80, v80
    v_exp_f32 v81, v81
    v_exp_f32 v82, v82
    v_exp_f32 v83, v83
    v_mfma_f32_32x32x16_bf16 v[96:111], a[4:7], v[36:39], v[96:111]
    ds_read_b128 a[12:15], v2 offset:64512
    v_exp_f32 v84, v84
    v_exp_f32 v85, v85
    v_exp_f32 v86, v86
    v_exp_f32 v87, v87
    v_smfmac_f32_32x32x32_bf16 v[160:175], a[56:59], v[64:71], v15
    s_waitcnt lgkmcnt(0)
    s_barrier
    v_exp_f32 v88, v88
    v_exp_f32 v89, v89
    v_exp_f32 v90, v90
    v_exp_f32 v91, v91
    v_smfmac_f32_32x32x32_bf16 v[160:175], a[60:63], v[72:79], v15
    ds_read_b128 a[48:51], v14 offset:0
    ds_read_b128 a[52:55], v14 offset:1024
    v_exp_f32 v92, v92
    v_exp_f32 v93, v93
    v_exp_f32 v94, v94
    v_exp_f32 v95, v95
    v_mfma_f32_32x32x16_bf16 v[112:127], a[0:3], v[40:43], 0
    v_exp_f32 v96, v96
    v_exp_f32 v97, v97
    v_exp_f32 v98, v98
    v_exp_f32 v99, v99
    v_mfma_f32_32x32x16_bf16 v[112:127], a[4:7], v[44:47], v[112:127]
    v_exp_f32 v100, v100
    v_exp_f32 v101, v101
    v_exp_f32 v102, v102
    v_exp_f32 v103, v103
    v_smfmac_f32_32x32x32_bf16 v[176:191], a[56:59], v[80:87], v15
    v_exp_f32 v104, v104
    v_exp_f32 v105, v105
    v_exp_f32 v106, v106
    v_exp_f32 v107, v107
    v_smfmac_f32_32x32x32_bf16 v[176:191], a[60:63], v[88:95], v15
    s_waitcnt lgkmcnt(0)
    v_exp_f32 v108, v108
    v_exp_f32 v109, v109
    v_exp_f32 v110, v110
    v_exp_f32 v111, v111
    v_mfma_f32_32x32x16_bf16 v[64:79], a[48:51], v[32:35], 0
    ds_read_b128 a[56:59], v14 offset:2048
    v_exp_f32 v112, v112
    v_exp_f32 v113, v113
    v_exp_f32 v114, v114
    v_exp_f32 v115, v115
    v_mfma_f32_32x32x16_bf16 v[64:79], a[52:55], v[36:39], v[64:79]
    ds_read_b128 a[60:63], v14 offset:3072
    v_exp_f32 v116, v116
    v_exp_f32 v117, v117
    v_exp_f32 v118, v118
    v_exp_f32 v119, v119
    v_smfmac_f32_32x32x32_bf16 v[160:175], a[8:11], v[96:103], v15
    v_exp_f32 v120, v120
    v_exp_f32 v121, v121
    v_exp_f32 v122, v122
    v_exp_f32 v123, v123
    v_smfmac_f32_32x32x32_bf16 v[160:175], a[12:15], v[104:111], v15
    ds_read_b128 a[0:3], v14 offset:4096
    ds_read_b128 a[4:7], v14 offset:5120
    v_exp_f32 v124, v124
    v_exp_f32 v125, v125
    v_exp_f32 v126, v126
    v_exp_f32 v127, v127
    v_mfma_f32_32x32x16_bf16 v[80:95], a[48:51], v[40:43], 0
    v_exp_f32 v64, v64
    v_exp_f32 v65, v65
    v_exp_f32 v66, v66
    v_exp_f32 v67, v67
    v_mfma_f32_32x32x16_bf16 v[80:95], a[52:55], v[44:47], v[80:95]
    v_exp_f32 v68, v68
    v_exp_f32 v69, v69
    v_exp_f32 v70, v70
    v_exp_f32 v71, v71
    v_smfmac_f32_32x32x32_bf16 v[176:191], a[8:11], v[112:119], v15
    v_exp_f32 v72, v72
    v_exp_f32 v73, v73
    v_exp_f32 v74, v74
    v_exp_f32 v75, v75
    v_smfmac_f32_32x32x32_bf16 v[176:191], a[12:15], v[120:127], v15
    s_waitcnt lgkmcnt(0)
    v_exp_f32 v76, v76
    v_exp_f32 v77, v77
    v_exp_f32 v78, v78
    v_exp_f32 v79, v79
    v_mfma_f32_32x32x16_bf16 v[96:111], a[0:3], v[32:35], 0
    ds_read_b128 a[8:11], v14 offset:6144
    v_exp_f32 v80, v80
    v_exp_f32 v81, v81
    v_exp_f32 v82, v82
    v_exp_f32 v83, v83
    v_mfma_f32_32x32x16_bf16 v[96:111], a[4:7], v[36:39], v[96:111]
    ds_read_b128 a[12:15], v14 offset:7168
    v_exp_f32 v84, v84
    v_exp_f32 v85, v85
    v_exp_f32 v86, v86
    v_exp_f32 v87, v87
    v_smfmac_f32_32x32x32_bf16 v[160:175], a[56:59], v[64:71], v15
    v_exp_f32 v88, v88
    v_exp_f32 v89, v89
    v_exp_f32 v90, v90
    v_exp_f32 v91, v91
    v_smfmac_f32_32x32x32_bf16 v[160:175], a[60:63], v[72:79], v15
    ds_read_b128 a[48:51], v14 offset:8192
    ds_read_b128 a[52:55], v14 offset:9216
    v_exp_f32 v92, v92
    v_exp_f32 v93, v93
    v_exp_f32 v94, v94
    v_exp_f32 v95, v95
    v_mfma_f32_32x32x16_bf16 v[112:127], a[0:3], v[40:43], 0
    v_exp_f32 v96, v96
    v_exp_f32 v97, v97
    v_exp_f32 v98, v98
    v_exp_f32 v99, v99
    v_mfma_f32_32x32x16_bf16 v[112:127], a[4:7], v[44:47], v[112:127]
    v_exp_f32 v100, v100
    v_exp_f32 v101, v101
    v_exp_f32 v102, v102
    v_exp_f32 v103, v103
    v_smfmac_f32_32x32x32_bf16 v[176:191], a[56:59], v[80:87], v15
    v_exp_f32 v104, v104
    v_exp_f32 v105, v105
    v_exp_f32 v106, v106
    v_exp_f32 v107, v107
    v_smfmac_f32_32x32x32_bf16 v[176:191], a[60:63], v[88:95], v15
    s_waitcnt lgkmcnt(0)
    v_exp_f32 v108, v108
    v_exp_f32 v109, v109
    v_exp_f32 v110, v110
    v_exp_f32 v111, v111
    v_mfma_f32_32x32x16_bf16 v[64:79], a[48:51], v[32:35], 0
    ds_read_b128 a[56:59], v14 offset:10240
    v_exp_f32 v112, v112
    v_exp_f32 v113, v113
    v_exp_f32 v114, v114
    v_exp_f32 v115, v115
    v_mfma_f32_32x32x16_bf16 v[64:79], a[52:55], v[36:39], v[64:79]
    ds_read_b128 a[60:63], v14 offset:11264
    v_exp_f32 v116, v116
    v_exp_f32 v117, v117
    v_exp_f32 v118, v118
    v_exp_f32 v119, v119
    v_smfmac_f32_32x32x32_bf16 v[160:175], a[8:11], v[96:103], v15
    v_exp_f32 v120, v120
    v_exp_f32 v121, v121
    v_exp_f32 v122, v122
    v_exp_f32 v123, v123
    v_smfmac_f32_32x32x32_bf16 v[160:175], a[12:15], v[104:111], v15
    ds_read_b128 a[0:3], v14 offset:12288
    ds_read_b128 a[4:7], v14 offset:13312
    v_exp_f32 v124, v124
    v_exp_f32 v125, v125
    v_exp_f32 v126, v126
    v_exp_f32 v127, v127
    v_mfma_f32_32x32x16_bf16 v[80:95], a[48:51], v[40:43], 0
    v_exp_f32 v64, v64
    v_exp_f32 v65, v65
    v_exp_f32 v66, v66
    v_exp_f32 v67, v67
    v_mfma_f32_32x32x16_bf16 v[80:95], a[52:55], v[44:47], v[80:95]
    v_exp_f32 v68, v68
    v_exp_f32 v69, v69
    v_exp_f32 v70, v70
    v_exp_f32 v71, v71
    v_smfmac_f32_32x32x32_bf16 v[176:191], a[8:11], v[112:119], v15
    v_exp_f32 v72, v72
    v_exp_f32 v73, v73
    v_exp_f32 v74, v74
    v_exp_f32 v75, v75
    v_smfmac_f32_32x32x32_bf16 v[176:191], a[12:15], v[120:127], v15
    s_waitcnt lgkmcnt(0)
    v_exp_f32 v76, v76
    v_exp_f32 v77, v77
    v_exp_f32 v78, v78
    v_exp_f32 v79, v79
    v_mfma_f32_32x32x16_bf16 v[96:111], a[0:3], v[32:35], 0
    ds_read_b128 a[8:11], v14 offset:14336
    v_exp_f32 v80, v80
    v_exp_f32 v81, v81
    v_exp_f32 v82, v82
    v_exp_f32 v83, v83
    v_mfma_f32_32x32x16_bf16 v[96:111], a[4:7], v[36:39], v[96:111]
    ds_read_b128 a[12:15], v14 offset:15360
    v_exp_f32 v84, v84
    v_exp_f32 v85, v85
    v_exp_f32 v86, v86
    v_exp_f32 v87, v87
    v_smfmac_f32_32x32x32_bf16 v[160:175], a[56:59], v[64:71], v15
    v_exp_f32 v88, v88
    v_exp_f32 v89, v89
    v_exp_f32 v90, v90
    v_exp_f32 v91, v91
    v_smfmac_f32_32x32x32_bf16 v[160:175], a[60:63], v[72:79], v15
    ds_read_b128 a[48:51], v14 offset:16384
    ds_read_b128 a[52:55], v14 offset:17408
    v_exp_f32 v92, v92
    v_exp_f32 v93, v93
    v_exp_f32 v94, v94
    v_exp_f32 v95, v95
    v_mfma_f32_32x32x16_bf16 v[112:127], a[0:3], v[40:43], 0
    v_exp_f32 v96, v96
    v_exp_f32 v97, v97
    v_exp_f32 v98, v98
    v_exp_f32 v99, v99
    v_mfma_f32_32x32x16_bf16 v[112:127], a[4:7], v[44:47], v[112:127]
    v_exp_f32 v100, v100
    v_exp_f32 v101, v101
    v_exp_f32 v102, v102
    v_exp_f32 v103, v103
    v_smfmac_f32_32x32x32_bf16 v[176:191], a[56:59], v[80:87], v15
    v_exp_f32 v104, v104
    v_exp_f32 v105, v105
    v_exp_f32 v106, v106
    v_exp_f32 v107, v107
    v_smfmac_f32_32x32x32_bf16 v[176:191], a[60:63], v[88:95], v15
    s_waitcnt lgkmcnt(0)
    v_exp_f32 v108, v108
    v_exp_f32 v109, v109
    v_exp_f32 v110, v110
    v_exp_f32 v111, v111
    v_mfma_f32_32x32x16_bf16 v[64:79], a[48:51], v[32:35], 0
    ds_read_b128 a[56:59], v14 offset:18432
    v_exp_f32 v112, v112
    v_exp_f32 v113, v113
    v_exp_f32 v114, v114
    v_exp_f32 v115, v115
    v_mfma_f32_32x32x16_bf16 v[64:79], a[52:55], v[36:39], v[64:79]
    ds_read_b128 a[60:63], v14 offset:19456
    v_exp_f32 v116, v116
    v_exp_f32 v117, v117
    v_exp_f32 v118, v118
    v_exp_f32 v119, v119
    v_smfmac_f32_32x32x32_bf16 v[160:175], a[8:11], v[96:103], v15
    v_exp_f32 v120, v120
    v_exp_f32 v121, v121
    v_exp_f32 v122, v122
    v_exp_f32 v123, v123
    v_smfmac_f32_32x32x32_bf16 v[160:175], a[12:15], v[104:111], v15
    ds_read_b128 a[0:3], v14 offset:20480
    ds_read_b128 a[4:7], v14 offset:21504
    v_exp_f32 v124, v124
    v_exp_f32 v125, v125
    v_exp_f32 v126, v126
    v_exp_f32 v127, v127
    v_mfma_f32_32x32x16_bf16 v[80:95], a[48:51], v[40:43], 0
    v_exp_f32 v64, v64
    v_exp_f32 v65, v65
    v_exp_f32 v66, v66
    v_exp_f32 v67, v67
    v_mfma_f32_32x32x16_bf16 v[80:95], a[52:55], v[44:47], v[80:95]
    v_exp_f32 v68, v68
    v_exp_f32 v69, v69
    v_exp_f32 v70, v70
    v_exp_f32 v71, v71
    v_smfmac_f32_32x32x32_bf16 v[176:191], a[8:11], v[112:119], v15
    v_exp_f32 v72, v72
    v_exp_f32 v73, v73
    v_exp_f32 v74, v74
    v_exp_f32 v75, v75
    v_smfmac_f32_32x32x32_bf16 v[176:191], a[12:15], v[120:127], v15
    s_waitcnt lgkmcnt(0)
    v_exp_f32 v76, v76
    v_exp_f32 v77, v77
    v_exp_f32 v78, v78
    v_exp_f32 v79, v79
    v_mfma_f32_32x32x16_bf16 v[96:111], a[0:3], v[32:35], 0
    ds_read_b128 a[8:11], v14 offset:22528
    v_exp_f32 v80, v80
    v_exp_f32 v81, v81
    v_exp_f32 v82, v82
    v_exp_f32 v83, v83
    v_mfma_f32_32x32x16_bf16 v[96:111], a[4:7], v[36:39], v[96:111]
    ds_read_b128 a[12:15], v14 offset:23552
    v_exp_f32 v84, v84
    v_exp_f32 v85, v85
    v_exp_f32 v86, v86
    v_exp_f32 v87, v87
    v_smfmac_f32_32x32x32_bf16 v[160:175], a[56:59], v[64:71], v15
    v_exp_f32 v88, v88
    v_exp_f32 v89, v89
    v_exp_f32 v90, v90
    v_exp_f32 v91, v91
    v_smfmac_f32_32x32x32_bf16 v[160:175], a[60:63], v[72:79], v15
    ds_read_b128 a[48:51], v14 offset:24576
    ds_read_b128 a[52:55], v14 offset:25600
    v_exp_f32 v92, v92
    v_exp_f32 v93, v93
    v_exp_f32 v94, v94
    v_exp_f32 v95, v95
    v_mfma_f32_32x32x16_bf16 v[112:127], a[0:3], v[40:43], 0
    v_exp_f32 v96, v96
    v_exp_f32 v97, v97
    v_exp_f32 v98, v98
    v_exp_f32 v99, v99
    v_mfma_f32_32x32x16_bf16 v[112:127], a[4:7], v[44:47], v[112:127]
    v_exp_f32 v100, v100
    v_exp_f32 v101, v101
    v_exp_f32 v102, v102
    v_exp_f32 v103, v103
    v_smfmac_f32_32x32x32_bf16 v[176:191], a[56:59], v[80:87], v15
    v_exp_f32 v104, v104
    v_exp_f32 v105, v105
    v_exp_f32 v106, v106
    v_exp_f32 v107, v107
    v_smfmac_f32_32x32x32_bf16 v[176:191], a[60:63], v[88:95], v15
    s_waitcnt lgkmcnt(0)
    v_exp_f32 v108, v108
    v_exp_f32 v109, v109
    v_exp_f32 v110, v110
    v_exp_f32 v111, v111
    v_mfma_f32_32x32x16_bf16 v[64:79], a[48:51], v[32:35], 0
    ds_read_b128 a[56:59], v14 offset:26624
    v_exp_f32 v112, v112
    v_exp_f32 v113, v113
    v_exp_f32 v114, v114
    v_exp_f32 v115, v115
    v_mfma_f32_32x32x16_bf16 v[64:79], a[52:55], v[36:39], v[64:79]
    ds_read_b128 a[60:63], v14 offset:27648
    v_exp_f32 v116, v116
    v_exp_f32 v117, v117
    v_exp_f32 v118, v118
    v_exp_f32 v119, v119
    v_smfmac_f32_32x32x32_bf16 v[160:175], a[8:11], v[96:103], v15
    v_exp_f32 v120, v120
    v_exp_f32 v121, v121
    v_exp_f32 v122, v122
    v_exp_f32 v123, v123
    v_smfmac_f32_32x32x32_bf16 v[160:175], a[12:15], v[104:111], v15
    ds_read_b128 a[0:3], v14 offset:28672
    ds_read_b128 a[4:7], v14 offset:29696
    v_exp_f32 v124, v124
    v_exp_f32 v125, v125
    v_exp_f32 v126, v126
    v_exp_f32 v127, v127
    v_mfma_f32_32x32x16_bf16 v[80:95], a[48:51], v[40:43], 0
    v_exp_f32 v64, v64
    v_exp_f32 v65, v65
    v_exp_f32 v66, v66
    v_exp_f32 v67, v67
    v_mfma_f32_32x32x16_bf16 v[80:95], a[52:55], v[44:47], v[80:95]
    v_exp_f32 v68, v68
    v_exp_f32 v69, v69
    v_exp_f32 v70, v70
    v_exp_f32 v71, v71
    v_smfmac_f32_32x32x32_bf16 v[176:191], a[8:11], v[112:119], v15
    v_exp_f32 v72, v72
    v_exp_f32 v73, v73
    v_exp_f32 v74, v74
    v_exp_f32 v75, v75
    v_smfmac_f32_32x32x32_bf16 v[176:191], a[12:15], v[120:127], v15
    s_waitcnt lgkmcnt(0)
    v_exp_f32 v76, v76
    v_exp_f32 v77, v77
    v_exp_f32 v78, v78
    v_exp_f32 v79, v79
    v_mfma_f32_32x32x16_bf16 v[96:111], a[0:3], v[32:35], 0
    ds_read_b128 a[8:11], v14 offset:30720
    v_exp_f32 v80, v80
    v_exp_f32 v81, v81
    v_exp_f32 v82, v82
    v_exp_f32 v83, v83
    v_mfma_f32_32x32x16_bf16 v[96:111], a[4:7], v[36:39], v[96:111]
    ds_read_b128 a[12:15], v14 offset:31744
    v_exp_f32 v84, v84
    v_exp_f32 v85, v85
    v_exp_f32 v86, v86
    v_exp_f32 v87, v87
    v_smfmac_f32_32x32x32_bf16 v[160:175], a[56:59], v[64:71], v15
    s_waitcnt lgkmcnt(0)
    s_barrier
    v_exp_f32 v88, v88
    v_exp_f32 v89, v89
    v_exp_f32 v90, v90
    v_exp_f32 v91, v91
    v_smfmac_f32_32x32x32_bf16 v[160:175], a[60:63], v[72:79], v15
    ds_read_b128 a[48:51], v2 offset:0
    ds_read_b128 a[52:55], v2 offset:1024
    v_exp_f32 v92, v92
    v_exp_f32 v93, v93
    v_exp_f32 v94, v94
    v_exp_f32 v95, v95
    v_mfma_f32_32x32x16_bf16 v[112:127], a[0:3], v[40:43], 0
    v_exp_f32 v96, v96
    v_exp_f32 v97, v97
    v_exp_f32 v98, v98
    v_exp_f32 v99, v99
    v_mfma_f32_32x32x16_bf16 v[112:127], a[4:7], v[44:47], v[112:127]
    v_exp_f32 v100, v100
    v_exp_f32 v101, v101
    v_exp_f32 v102, v102
    v_exp_f32 v103, v103
    v_smfmac_f32_32x32x32_bf16 v[176:191], a[56:59], v[80:87], v15
    v_exp_f32 v104, v104
    v_exp_f32 v105, v105
    v_exp_f32 v106, v106
    v_exp_f32 v107, v107
    v_smfmac_f32_32x32x32_bf16 v[176:191], a[60:63], v[88:95], v15
    s_waitcnt lgkmcnt(0)
    v_exp_f32 v108, v108
    v_exp_f32 v109, v109
    v_exp_f32 v110, v110
    v_exp_f32 v111, v111
    v_mfma_f32_32x32x16_bf16 v[64:79], a[48:51], v[32:35], 0
    ds_read_b128 a[56:59], v2 offset:2048
    v_exp_f32 v112, v112
    v_exp_f32 v113, v113
    v_exp_f32 v114, v114
    v_exp_f32 v115, v115
    v_mfma_f32_32x32x16_bf16 v[64:79], a[52:55], v[36:39], v[64:79]
    ds_read_b128 a[60:63], v2 offset:3072
    v_exp_f32 v116, v116
    v_exp_f32 v117, v117
    v_exp_f32 v118, v118
    v_exp_f32 v119, v119
    v_smfmac_f32_32x32x32_bf16 v[160:175], a[8:11], v[96:103], v15
    v_exp_f32 v120, v120
    v_exp_f32 v121, v121
    v_exp_f32 v122, v122
    v_exp_f32 v123, v123
    v_smfmac_f32_32x32x32_bf16 v[160:175], a[12:15], v[104:111], v15
    ds_read_b128 a[0:3], v2 offset:4096
    ds_read_b128 a[4:7], v2 offset:5120
    v_exp_f32 v124, v124
    v_exp_f32 v125, v125
    v_exp_f32 v126, v126
    v_exp_f32 v127, v127
    v_mfma_f32_32x32x16_bf16 v[80:95], a[48:51], v[40:43], 0
    v_exp_f32 v64, v64
    v_exp_f32 v65, v65
    v_exp_f32 v66, v66
    v_exp_f32 v67, v67
    v_mfma_f32_32x32x16_bf16 v[80:95], a[52:55], v[44:47], v[80:95]
    v_exp_f32 v68, v68
    v_exp_f32 v69, v69
    v_exp_f32 v70, v70
    v_exp_f32 v71, v71
    v_smfmac_f32_32x32x32_bf16 v[176:191], a[8:11], v[112:119], v15
    v_exp_f32 v72, v72
    v_exp_f32 v73, v73
    v_exp_f32 v74, v74
    v_exp_f32 v75, v75
    v_smfmac_f32_32x32x32_bf16 v[176:191], a[12:15], v[120:127], v15
    s_waitcnt lgkmcnt(0)
    v_exp_f32 v76, v76
    v_exp_f32 v77, v77
    v_exp_f32 v78, v78
    v_exp_f32 v79, v79
    v_mfma_f32_32x32x16_bf16 v[96:111], a[0:3], v[32:35], 0
    ds_read_b128 a[8:11], v2 offset:6144
    v_exp_f32 v80, v80
    v_exp_f32 v81, v81
    v_exp_f32 v82, v82
    v_exp_f32 v83, v83
    v_mfma_f32_32x32x16_bf16 v[96:111], a[4:7], v[36:39], v[96:111]
    ds_read_b128 a[12:15], v2 offset:7168
    v_exp_f32 v84, v84
    v_exp_f32 v85, v85
    v_exp_f32 v86, v86
    v_exp_f32 v87, v87
    v_smfmac_f32_32x32x32_bf16 v[160:175], a[56:59], v[64:71], v15
    v_exp_f32 v88, v88
    v_exp_f32 v89, v89
    v_exp_f32 v90, v90
    v_exp_f32 v91, v91
    v_smfmac_f32_32x32x32_bf16 v[160:175], a[60:63], v[72:79], v15
    ds_read_b128 a[48:51], v2 offset:8192
    ds_read_b128 a[52:55], v2 offset:9216
    v_exp_f32 v92, v92
    v_exp_f32 v93, v93
    v_exp_f32 v94, v94
    v_exp_f32 v95, v95
    v_mfma_f32_32x32x16_bf16 v[112:127], a[0:3], v[40:43], 0
    v_exp_f32 v96, v96
    v_exp_f32 v97, v97
    v_exp_f32 v98, v98
    v_exp_f32 v99, v99
    v_mfma_f32_32x32x16_bf16 v[112:127], a[4:7], v[44:47], v[112:127]
    v_exp_f32 v100, v100
    v_exp_f32 v101, v101
    v_exp_f32 v102, v102
    v_exp_f32 v103, v103
    v_smfmac_f32_32x32x32_bf16 v[176:191], a[56:59], v[80:87], v15
    v_exp_f32 v104, v104
    v_exp_f32 v105, v105
    v_exp_f32 v106, v106
    v_exp_f32 v107, v107
    v_smfmac_f32_32x32x32_bf16 v[176:191], a[60:63], v[88:95], v15
    s_waitcnt lgkmcnt(0)
    v_exp_f32 v108, v108
    v_exp_f32 v109, v109
    v_exp_f32 v110, v110
    v_exp_f32 v111, v111
    v_mfma_f32_32x32x16_bf16 v[64:79], a[48:51], v[32:35], 0
    ds_read_b128 a[56:59], v2 offset:10240
    v_exp_f32 v112, v112
    v_exp_f32 v113, v113
    v_exp_f32 v114, v114
    v_exp_f32 v115, v115
    v_mfma_f32_32x32x16_bf16 v[64:79], a[52:55], v[36:39], v[64:79]
    ds_read_b128 a[60:63], v2 offset:11264
    v_exp_f32 v116, v116
    v_exp_f32 v117, v117
    v_exp_f32 v118, v118
    v_exp_f32 v119, v119
    v_smfmac_f32_32x32x32_bf16 v[160:175], a[8:11], v[96:103], v15
    v_exp_f32 v120, v120
    v_exp_f32 v121, v121
    v_exp_f32 v122, v122
    v_exp_f32 v123, v123
    v_smfmac_f32_32x32x32_bf16 v[160:175], a[12:15], v[104:111], v15
    ds_read_b128 a[0:3], v2 offset:12288
    ds_read_b128 a[4:7], v2 offset:13312
    v_exp_f32 v124, v124
    v_exp_f32 v125, v125
    v_exp_f32 v126, v126
    v_exp_f32 v127, v127
    v_mfma_f32_32x32x16_bf16 v[80:95], a[48:51], v[40:43], 0
    v_exp_f32 v64, v64
    v_exp_f32 v65, v65
    v_exp_f32 v66, v66
    v_exp_f32 v67, v67
    v_mfma_f32_32x32x16_bf16 v[80:95], a[52:55], v[44:47], v[80:95]
L_pad6:
    s_cbranch_execz L_padret6
    v_exp_f32 v68, v68
    v_exp_f32 v69, v69
    v_exp_f32 v70, v70
    v_exp_f32 v71, v71
    v_smfmac_f32_32x32x32_bf16 v[176:191], a[8:11], v[112:119], v15
    v_exp_f32 v72, v72
    v_exp_f32 v73, v73
    v_exp_f32 v74, v74
    v_exp_f32 v75, v75
    v_smfmac_f32_32x32x32_bf16 v[176:191], a[12:15], v[120:127], v15
    s_waitcnt lgkmcnt(0)
    v_exp_f32 v76, v76
    v_exp_f32 v77, v77
    v_exp_f32 v78, v78
    v_exp_f32 v79, v79
    v_mfma_f32_32x32x16_bf16 v[96:111], a[0:3], v[32:35], 0
    ds_read_b128 a[8:11], v2 offset:14336
    v_exp_f32 v80, v80
    v_exp_f32 v81, v81
    v_exp_f32 v82, v82
    v_exp_f32 v83, v83
    v_mfma_f32_32x32x16_bf16 v[96:111], a[4:7], v[36:39], v[96:111]
    ds_read_b128 a[12:15], v2 offset:15360
    v_exp_f32 v84, v84
    v_exp_f32 v85, v85
    v_exp_f32 v86, v86
    v_exp_f32 v87, v87
    v_smfmac_f32_32x32x32_bf16 v[160:175], a[56:59], v[64:71], v15
    v_exp_f32 v88, v88
    v_exp_f32 v89, v89
    v_exp_f32 v90, v90
    v_exp_f32 v91, v91
    v_smfmac_f32_32x32x32_bf16 v[160:175], a[60:63], v[72:79], v15
    ds_read_b128 a[48:51], v2 offset:16384
    ds_read_b128 a[52:55], v2 offset:17408
    v_exp_f32 v92, v92
    v_exp_f32 v93, v93
    v_exp_f32 v94, v94
    v_exp_f32 v95, v95
    v_mfma_f32_32x32x16_bf16 v[112:127], a[0:3], v[40:43], 0
    v_exp_f32 v96, v96
    v_exp_f32 v97, v97
    v_exp_f32 v98, v98
    v_exp_f32 v99, v99
    v_mfma_f32_32x32x16_bf16 v[112:127], a[4:7], v[44:47], v[112:127]
    v_exp_f32 v100, v100
    v_exp_f32 v101, v101
    v_exp_f32 v102, v102
    v_exp_f32 v103, v103
    v_smfmac_f32_32x32x32_bf16 v[176:191], a[56:59], v[80:87], v15
    v_exp_f32 v104, v104
    v_exp_f32 v105, v105
    v_exp_f32 v106, v106
    v_exp_f32 v107, v107
    v_smfmac_f32_32x32x32_bf16 v[176:191], a[60:63], v[88:95], v15
    s_waitcnt lgkmcnt(0)
    v_exp_f32 v108, v108
    v_exp_f32 v109, v109
    v_exp_f32 v110, v110
    v_exp_f32 v111, v111
    v_mfma_f32_32x32x16_bf16 v[64:79], a[48:51], v[32:35], 0
    ds_read_b128 a[56:59], v2 offset:18432
    v_exp_f32 v112, v112
    v_exp_f32 v113, v113
    v_exp_f32 v114, v114
    v_exp_f32 v115, v115
    v_mfma_f32_32x32x16_bf16 v[64:79], a[52:55], v[36:39], v[64:79]
    ds_read_b128 a[60:63], v2 offset:19456
    v_exp_f32 v116, v116
    v_exp_f32 v117, v117
    v_exp_f32 v118, v118
    v_exp_f32 v119, v119
    v_smfmac_f32_32x32x32_bf16 v[160:175], a[8:11], v[96:103], v15
    v_exp_f32 v120, v120
    v_exp_f32 v121, v121
    v_exp_f32 v122, v122
    v_exp_f32 v123, v123
    v_smfmac_f32_32x32x32_bf16 v[160:175], a[12:15], v[104:111], v15
    ds_read_b128 a[0:3], v2 offset:20480
    ds_read_b128 a[4:7], v2 offset:21504
    v_exp_f32 v124, v124
    v_exp_f32 v125, v125
    v_exp_f32 v126, v126
    v_exp_f32 v127, v127
    v_mfma_f32_32x32x16_bf16 v[80:95], a[48:51], v[40:43], 0
    v_exp_f32 v64, v64
    v_exp_f32 v65, v65
    v_exp_f32 v66, v66
    v_exp_f32 v67, v67
    v_mfma_f32_32x32x16_bf16 v[80:95], a[52:55], v[44:47], v[80:95]
    v_exp_f32 v68, v68
    v_exp_f32 v69, v69
    v_exp_f32 v70, v70
    v_exp_f32 v71, v71
    v_smfmac_f32_32x32x32_bf16 v[176:191], a[8:11], v[112:119], v15
    v_exp_f32 v72, v72
    v_exp_f32 v73, v73
    v_exp_f32 v74, v74
    v_exp_f32 v75, v75
    v_smfmac_f32_32x32x32_bf16 v[176:191], a[12:15], v[120:127], v15
    s_waitcnt lgkmcnt(0)
    v_exp_f32 v76, v76
    v_exp_f32 v77, v77
    v_exp_f32 v78, v78
    v_exp_f32 v79, v79
    v_mfma_f32_32x32x16_bf16 v[96:111], a[0:3], v[32:35], 0
    ds_read_b128 a[8:11], v2 offset:22528
    v_exp_f32 v80, v80
    v_exp_f32 v81, v81
    v_exp_f32 v82, v82
    v_exp_f32 v83, v83
    v_mfma_f32_32x32x16_bf16 v[96:111], a[4:7], v[36:39], v[96:111]
    ds_read_b128 a[12:15], v2 offset:23552
    v_exp_f32 v84, v84
    v_exp_f32 v85, v85
    v_exp_f32 v86, v86
    v_exp_f32 v87, v87
    v_smfmac_f32_32x32x32_bf16 v[160:175], a[56:59], v[64:71], v15
    v_exp_f32 v88, v88
    v_exp_f32 v89, v89
    v_exp_f32 v90, v90
    v_exp_f32 v91, v91
    v_smfmac_f32_32x32x32_bf16 v[160:175], a[60:63], v[72:79], v15
    ds_read_b128 a[48:51], v2 offset:24576
    ds_read_b128 a[52:55], v2 offset:25600
    v_exp_f32 v92, v92
    v_exp_f32 v93, v93
    v_exp_f32 v94, v94
    v_exp_f32 v95, v95
    v_mfma_f32_32x32x16_bf16 v[112:127], a[0:3], v[40:43], 0
    v_exp_f32 v96, v96
    v_exp_f32 v97, v97
    v_exp_f32 v98, v98
    v_exp_f32 v99, v99
    v_mfma_f32_32x32x16_bf16 v[112:127], a[4:7], v[44:47], v[112:127]
    v_exp_f32 v100, v100
    v_exp_f32 v101, v101
    v_exp_f32 v102, v102
    v_exp_f32 v103, v103
    v_smfmac_f32_32x32x32_bf16 v[176:191], a[56:59], v[80:87], v15
    v_exp_f32 v104, v104
    v_exp_f32 v105, v105
    v_exp_f32 v106, v106
    v_exp_f32 v107, v107
    v_smfmac_f32_32x32x32_bf16 v[176:191], a[60:63], v[88:95], v15
    s_waitcnt lgkmcnt(0)
    v_exp_f32 v108, v108
    v_exp_f32 v109, v109
    v_exp_f32 v110, v110
    v_exp_f32 v111, v111
    v_mfma_f32_32x32x16_bf16 v[64:79], a[48:51], v[32:35], 0
    ds_read_b128 a[56:59], v2 offset:26624
    v_exp_f32 v112, v112
    v_exp_f32 v113, v113
    v_exp_f32 v114, v114
    v_exp_f32 v115, v115
    v_mfma_f32_32x32x16_bf16 v[64:79], a[52:55], v[36:39], v[64:79]
    ds_read_b128 a[60:63], v2 offset:27648
    v_exp_f32 v116, v116
    v_exp_f32 v117, v117
    v_exp_f32 v118, v118
    v_exp_f32 v119, v119
    v_smfmac_f32_32x32x32_bf16 v[160:175], a[8:11], v[96:103], v15
    v_exp_f32 v120, v120
    v_exp_f32 v121, v121
    v_exp_f32 v122, v122
    v_exp_f32 v123, v123
    v_smfmac_f32_32x32x32_bf16 v[160:175], a[12:15], v[104:111], v15
    ds_read_b128 a[0:3], v2 offset:28672
    ds_read_b128 a[4:7], v2 offset:29696
    v_exp_f32 v124, v124
    v_exp_f32 v125, v125
    v_exp_f32 v126, v126
    v_exp_f32 v127, v127
    v_mfma_f32_32x32x16_bf16 v[80:95], a[48:51], v[40:43], 0
    v_exp_f32 v64, v64
    v_exp_f32 v65, v65
    v_exp_f32 v66, v66
    v_exp_f32 v67, v67
    v_mfma_f32_32x32x16_bf16 v[80:95], a[52:55], v[44:47], v[80:95]
    v_exp_f32 v68, v68
    v_exp_f32 v69, v69
    v_exp_f32 v70, v70
    v_exp_f32 v71, v71
    v_smfmac_f32_32x32x32_bf16 v[176:191], a[8:11], v[112:119], v15
    v_exp_f32 v72, v72
    v_exp_f32 v73, v73
    v_exp_f32 v74, v74
    v_exp_f32 v75, v75
    v_smfmac_f32_32x32x32_bf16 v[176:191], a[12:15], v[120:127], v15
    s_waitcnt lgkmcnt(0)
    v_exp_f32 v76, v76
    v_exp_f32 v77, v77
    v_exp_f32 v78, v78
    v_exp_f32 v79, v79
    v_mfma_f32_32x32x16_bf16 v[96:111], a[0:3], v[32:35], 0
    ds_read_b128 a[8:11], v2 offset:30720
    v_exp_f32 v80, v80
    v_exp_f32 v81, v81
    v_exp_f32 v82, v82
    v_exp_f32 v83, v83
    v_mfma_f32_32x32x16_bf16 v[96:111], a[4:7], v[36:39], v[96:111]
    ds_read_b128 a[12:15], v2 offset:31744
    v_exp_f32 v84, v84
    v_exp_f32 v85, v85
    v_exp_f32 v86, v86
    v_exp_f32 v87, v87
    v_smfmac_f32_32x32x32_bf16 v[160:175], a[56:59], v[64:71], v15
    v_exp_f32 v88, v88
    v_exp_f32 v89, v89
    v_exp_f32 v90, v90
    v_exp_f32 v91, v91
    v_smfmac_f32_32x32x32_bf16 v[160:175], a[60:63], v[72:79], v15
    v_exp_f32 v92, v92
    v_exp_f32 v93, v93
    v_exp_f32 v94, v94
    v_exp_f32 v95, v95
    v_mfma_f32_32x32x16_bf16 v[112:127], a[0:3], v[40:43], 0
    v_exp_f32 v96, v96
    v_exp_f32 v97, v97
    v_exp_f32 v98, v98
    v_exp_f32 v99, v99
    v_mfma_f32_32x32x16_bf16 v[112:127], a[4:7], v[44:47], v[112:127]
    v_exp_f32 v100, v100
    v_exp_f32 v101, v101
    v_exp_f32 v102, v102
    v_exp_f32 v103, v103
    v_smfmac_f32_32x32x32_bf16 v[176:191], a[56:59], v[80:87], v15
    v_exp_f32 v104, v104
    v_exp_f32 v105, v105
    v_exp_f32 v106, v106
    v_exp_f32 v107, v107
    v_smfmac_f32_32x32x32_bf16 v[176:191], a[60:63], v[88:95], v15
    s_waitcnt lgkmcnt(0)
    v_exp_f32 v108, v108
    v_exp_f32 v109, v109
    v_exp_f32 v110, v110
    v_exp_f32 v111, v111
    v_exp_f32 v112, v112
    v_exp_f32 v113, v113
    v_exp_f32 v114, v114
    v_exp_f32 v115, v115
    v_exp_f32 v116, v116
    v_exp_f32 v117, v117
    v_exp_f32 v118, v118
    v_exp_f32 v119, v119
    v_smfmac_f32_32x32x32_bf16 v[160:175], a[8:11], v[96:103], v15
    v_exp_f32 v120, v120
    v_exp_f32 v121, v121
    v_exp_f32 v122, v122
    v_exp_f32 v123, v123
    v_smfmac_f32_32x32x32_bf16 v[160:175], a[12:15], v[104:111], v15
    v_exp_f32 v124, v124
    v_exp_f32 v125, v125
    v_exp_f32 v126, v126
    v_exp_f32 v127, v127
    s_nop 1
    v_smfmac_f32_32x32x32_bf16 v[176:191], a[8:11], v[112:119], v15
    v_smfmac_f32_32x32x32_bf16 v[176:191], a[12:15], v[120:127], v15
    s_waitcnt lgkmcnt(0)
L_epi:
    s_nop 2
    v_mov_b32 v20, v172
    v_mov_b32 v21, v172
    s_nop 1
    v_permlane32_swap_b32 v20, v21
    v_med3_f32 v20, v21, s56, v30
    v_cmp_neq_f32 s[96:97], v20, v21
    v_rcp_f32 v21, v21
    s_nop 0
    v_pk_mul_f32 v[160:161], v[160:161], v[20:21] op_sel:[0,1] op_sel_hi:[1,1]
    v_pk_mul_f32 v[162:163], v[162:163], v[20:21] op_sel:[0,1] op_sel_hi:[1,1]
    v_pk_mul_f32 v[164:165], v[164:165], v[20:21] op_sel:[0,1] op_sel_hi:[1,1]
    v_pk_mul_f32 v[166:167], v[166:167], v[20:21] op_sel:[0,1] op_sel_hi:[1,1]
    v_pk_mul_f32 v[168:169], v[168:169], v[20:21] op_sel:[0,1] op_sel_hi:[1,1]
    v_pk_mul_f32 v[170:171], v[170:171], v[20:21] op_sel:[0,1] op_sel_hi:[1,1]
    v_pk_mul_f32 v[172:173], v[172:173], v[20:21] op_sel:[0,1] op_sel_hi:[1,1]
    v_pk_mul_f32 v[174:175], v[174:175], v[20:21] op_sel:[0,1] op_sel_hi:[1,1]
    v_cvt_pk_bf16_f32 v160, v160, v161
    v_cvt_pk_bf16_f32 v161, v162, v163
    v_cvt_pk_bf16_f32 v162, v164, v165
    v_cvt_pk_bf16_f32 v163, v166, v167
    v_cvt_pk_bf16_f32 v164, v168, v169
    v_cvt_pk_bf16_f32 v165, v170, v171
    v_cvt_pk_bf16_f32 v166, v172, v173
    v_cvt_pk_bf16_f32 v167, v174, v175
    v_cndmask_b32 v166, v166, 0, s[58:59]
    v_cndmask_b32 v167, v167, 0, s[58:59]
    buffer_store_dwordx4 v[160:163], v2, s[24:27], s54 offen offset:0 sc1
    buffer_store_dwordx4 v[164:167], v2, s[24:27], s54 offen offset:1024 sc1
    v_mov_b32 v20, v188
    v_mov_b32 v21, v188
    s_nop 1
    v_permlane32_swap_b32 v20, v21
    v_med3_f32 v20, v21, s56, v30
    v_cmp_neq_f32 vcc, v20, v21
    v_rcp_f32 v21, v21
    s_nop 0
    v_pk_mul_f32 v[176:177], v[176:177], v[20:21] op_sel:[0,1] op_sel_hi:[1,1]
    v_pk_mul_f32 v[178:179], v[178:179], v[20:21] op_sel:[0,1] op_sel_hi:[1,1]
    v_pk_mul_f32 v[180:181], v[180:181], v[20:21] op_sel:[0,1] op_sel_hi:[1,1]
    v_pk_mul_f32 v[182:183], v[182:183], v[20:21] op_sel:[0,1] op_sel_hi:[1,1]
    v_pk_mul_f32 v[184:185], v[184:185], v[20:21] op_sel:[0,1] op_sel_hi:[1,1]
    v_pk_mul_f32 v[186:187], v[186:187], v[20:21] op_sel:[0,1] op_sel_hi:[1,1]
    v_pk_mul_f32 v[188:189], v[188:189], v[20:21] op_sel:[0,1] op_sel_hi:[1,1]
    v_pk_mul_f32 v[190:191], v[190:191], v[20:21] op_sel:[0,1] op_sel_hi:[1,1]
    v_cvt_pk_bf16_f32 v176, v176, v177
    v_cvt_pk_bf16_f32 v177, v178, v179
    v_cvt_pk_bf16_f32 v178, v180, v181
    v_cvt_pk_bf16_f32 v179, v182, v183
    v_cvt_pk_bf16_f32 v180, v184, v185
    v_cvt_pk_bf16_f32 v181, v186, v187
    v_cvt_pk_bf16_f32 v182, v188, v189
    v_cvt_pk_bf16_f32 v183, v190, v191
    v_cndmask_b32 v182, v182, 0, s[58:59]
    v_cndmask_b32 v183, v183, 0, s[58:59]
    buffer_store_dwordx4 v[176:179], v2, s[24:27], s54 offen offset:2048 sc1
    buffer_store_dwordx4 v[180:183], v2, s[24:27], s54 offen offset:3072 sc1
    s_or_b64 vcc, vcc, s[96:97]
    s_cmp_lg_u32 s39, 0
    s_cselect_b64 vcc, 0, vcc
    s_nop 0
    s_cbranch_vccnz L_slow
    s_barrier
    s_waitcnt vmcnt(0)
    buffer_store_dword v17, v31, s[28:31], 0 offen sc1
    s_waitcnt vmcnt(0)
    s_cmp_lg_u32 s35, 0
    s_cbranch_scc1 L_cdone
    v_mov_b32 v22, 32768
    s_mov_b32 s38, 0
L_gate:
    buffer_load_dword v21, v19, s[28:31], 0 offen sc1
    s_add_u32 s38, s38, 1
    s_cmp_ge_u32 s38, 0x40000
    s_cbranch_scc1 L_gate_ok
    s_waitcnt vmcnt(0)
    v_cmp_ne_u32 vcc, s36, v21
    s_nop 1
    s_cbranch_vccz L_gate_ok
    s_and_b32 s67, vcc_lo, 54699
    s_cbranch_scc1 L_gate_no
    ds_write_b32 v22, v17
L_gate_no:
    s_branch L_gate
L_gate_ok:
    ds_write_b32 v22, v17 offset:4
    ds_write_b32 v22, v17
L_cdone:
    s_endpgm
L_slow:
    s_mov_b32 s39, 1
    s_waitcnt vmcnt(0)
    v_cndmask_b32 v38, v38, 0, s[58:59]
    v_cndmask_b32 v39, v39, 0, s[58:59]
    v_cndmask_b32 v46, v46, 0, s[58:59]
    v_cndmask_b32 v47, v47, 0, s[58:59]
    v_mov_b32 v20, 0xff800000
    v_mov_b32 v21, 0xff800000
    s_mov_b32 s67, 0
L_slow_max:
    buffer_load_dwordx4 v[128:131], v2, s[20:23], s67 offen sc1
    buffer_load_dwordx4 v[132:135], v2, s[20:23], s67 offen offset:1024 sc1
    s_waitcnt vmcnt(0)
    v_mfma_f32_32x32x16_bf16 v[64:79], v[128:131], v[32:35], 0
    v_mfma_f32_32x32x16_bf16 v[64:79], v[132:135], v[36:39], v[64:79]
    v_mfma_f32_32x32x16_bf16 v[80:95], v[128:131], v[40:43], 0
    v_mfma_f32_32x32x16_bf16 v[80:95], v[132:135], v[44:47], v[80:95]
    s_nop 7
    s_nop 3
    v_max3_f32 v20, v20, v64, v65
    v_max3_f32 v20, v20, v66, v67
    v_max3_f32 v20, v20, v68, v69
    v_max3_f32 v20, v20, v70, v71
    v_max3_f32 v20, v20, v72, v73
    v_max3_f32 v20, v20, v74, v75
    v_max3_f32 v20, v20, v76, v77
    v_max3_f32 v20, v20, v78, v79
    v_max3_f32 v21, v21, v80, v81
    v_max3_f32 v21, v21, v82, v83
    v_max3_f32 v21, v21, v84, v85
    v_max3_f32 v21, v21, v86, v87
    v_max3_f32 v21, v21, v88, v89
    v_max3_f32 v21, v21, v90, v91
    v_max3_f32 v21, v21, v92, v93
    v_max3_f32 v21, v21, v94, v95
    s_add_u32 s67, s67, 4096
    s_cmp_lt_u32 s67, 262144
    s_cbranch_scc1 L_slow_max
    v_mov_b32 v22, v20
    v_mov_b32 v23, v21
    s_nop 1
    v_permlane32_swap_b32 v20, v22
    v_permlane32_swap_b32 v21, v23
    v_max_f32 v20, v20, v22
    v_max_f32 v21, v21, v23
    v_sub_f32 v20, 0, v20
    v_and_b32 v22, 0xffff0000, v20
    v_sub_f32 v20, v20, v22
    v_and_b32 v23, 0xffff0000, v20
    v_sub_f32 v20, v20, v23
    v_lshrrev_b32 v22, 16, v22
    v_or_b32 v22, v22, v23
    v_lshrrev_b32 v20, 16, v20
    v_cndmask_b32 v38, v38, v22, s[58:59]
    v_cndmask_b32 v39, v39, v20, s[58:59]
    v_sub_f32 v21, 0, v21
    v_and_b32 v22, 0xffff0000, v21
    v_sub_f32 v21, v21, v22
    v_and_b32 v23, 0xffff0000, v21
    v_sub_f32 v21, v21, v23
    v_lshrrev_b32 v22, 16, v22
    v_or_b32 v22, v22, v23
    v_lshrrev_b32 v21, 16, v21
    v_cndmask_b32 v46, v46, v22, s[58:59]
    v_cndmask_b32 v47, v47, v21, s[58:59]
    v_mov_b32 v160, 0
    v_mov_b32 v161, 0
    v_mov_b32 v162, 0
    v_mov_b32 v163, 0
    v_mov_b32 v164, 0
    v_mov_b32 v165, 0
    v_mov_b32 v166, 0
    v_mov_b32 v167, 0
    v_mov_b32 v168, 0
    v_mov_b32 v169, 0
    v_mov_b32 v170, 0
    v_mov_b32 v171, 0
    v_mov_b32 v172, 0
    v_mov_b32 v173, 0
    v_mov_b32 v174, 0
    v_mov_b32 v175, 0
    v_mov_b32 v176, 0
    v_mov_b32 v177, 0
    v_mov_b32 v178, 0
    v_mov_b32 v179, 0
    v_mov_b32 v180, 0
    v_mov_b32 v181, 0
    v_mov_b32 v182, 0
    v_mov_b32 v183, 0
    v_mov_b32 v184, 0
    v_mov_b32 v185, 0
    v_mov_b32 v186, 0
    v_mov_b32 v187, 0
    v_mov_b32 v188, 0
    v_mov_b32 v189, 0
    v_mov_b32 v190, 0
    v_mov_b32 v191, 0
    s_mov_b32 s67, 0
L_slow_pv:
    buffer_load_dwordx4 v[128:131], v2, s[20:23], s67 offen sc1
    buffer_load_dwordx4 v[132:135], v2, s[20:23], s67 offen offset:1024 sc1
    buffer_load_dwordx4 v[136:139], v2, s[20:23], s67 offen offset:2048 sc1
    buffer_load_dwordx4 v[140:143], v2, s[20:23], s67 offen offset:3072 sc1
    s_waitcnt vmcnt(0)
    v_mfma_f32_32x32x16_bf16 v[64:79], v[128:131], v[32:35], 0
    v_mfma_f32_32x32x16_bf16 v[64:79], v[132:135], v[36:39], v[64:79]
    v_mfma_f32_32x32x16_bf16 v[80:95], v[128:131], v[40:43], 0
    v_mfma_f32_32x32x16_bf16 v[80:95], v[132:135], v[44:47], v[80:95]
    s_nop 7
    s_nop 3
    v_exp_f32 v64, v64
    v_exp_f32 v65, v65
    v_exp_f32 v66, v66
    v_exp_f32 v67, v67
    v_exp_f32 v68, v68
    v_exp_f32 v69, v69
    v_exp_f32 v70, v70
    v_exp_f32 v71, v71
    v_exp_f32 v72, v72
    v_exp_f32 v73, v73
    v_exp_f32 v74, v74
    v_exp_f32 v75, v75
    v_exp_f32 v76, v76
    v_exp_f32 v77, v77
    v_exp_f32 v78, v78
    v_exp_f32 v79, v79
    v_exp_f32 v80, v80
    v_exp_f32 v81, v81
    v_exp_f32 v82, v82
    v_exp_f32 v83, v83
    v_exp_f32 v84, v84
    v_exp_f32 v85, v85
    v_exp_f32 v86, v86
    v_exp_f32 v87, v87
    v_exp_f32 v88, v88
    v_exp_f32 v89, v89
    v_exp_f32 v90, v90
    v_exp_f32 v91, v91
    v_exp_f32 v92, v92
    v_exp_f32 v93, v93
    v_exp_f32 v94, v94
    v_exp_f32 v95, v95
    s_nop 1
    v_smfmac_f32_32x32x32_bf16 v[160:175], v[136:139], v[64:71], v15
    v_smfmac_f32_32x32x32_bf16 v[160:175], v[140:143], v[72:79], v15
    v_smfmac_f32_32x32x32_bf16 v[176:191], v[136:139], v[80:87], v15
    v_smfmac_f32_32x32x32_bf16 v[176:191], v[140:143], v[88:95], v15
    s_add_u32 s67, s67, 4096
    s_cmp_lt_u32 s67, 262144
    s_nop 7
    s_cbranch_scc1 L_slow_pv
    s_nop 3
    s_branch L_epi
L_codeend:
.section .rodata,"a"
.p2align 6
.amdhsa_kernel concat_heads__softmax_full_mha__mha_block__prompt_kernel
  .amdhsa_next_free_vgpr 256
  .amdhsa_next_free_sgpr 102
  .amdhsa_accum_offset 192
  .amdhsa_group_segment_fixed_size 0
  .amdhsa_kernarg_size 72
  .amdhsa_user_sgpr_count 2
  .amdhsa_user_sgpr_kernarg_segment_ptr 1
  .amdhsa_system_sgpr_workgroup_id_x 1
.end_amdhsa_kernel
```
